```python
import torch

def _softmax(x, axis=-1):
    return torch.softmax(x, dim=axis)

def _gelu(x):
    return torch.nn.functional.gelu(x, approximate='tanh')

def _silu(x):
    return torch.nn.functional.silu(x)

def _sigmoid(x):
    return torch.sigmoid(x)

def _layernorm(x, axis=-1, eps=1e-05):
    m = x.mean(dim=axis, keepdim=True)
    v = x.var(dim=axis, keepdim=True, unbiased=False)
    return (x - m) / torch.sqrt(v + eps)

def _scatter_add(tgt, idx, src, axis=0):
    return tgt.clone().index_add_(axis, idx, src)

def _segment_sum(src, seg, n):
    out = torch.zeros((n,) + src.shape[1:], dtype=src.dtype)
    return out.index_add_(0, seg, src)

def _pad(x, pw):
    flat = tuple((v for pair in reversed(pw) for v in pair))
    return torch.nn.functional.pad(x, flat)
kernel_name = 'standalone__conformer_family_zipformer__speech'

def setup_inputs():

    _w = lambda a: (lambda t: t.to(torch.bfloat16) if t.is_floating_point() else t)(torch.as_tensor(a))
    B, T, D, K, H = (2, 1000, 256, 31, 4)
    sc = 0.1
    return {'x': _w((lambda *s: torch.randn(*s, dtype=torch.bfloat16) * 0.8)(B, T, D)), 'w_ff1a': _w((lambda *s: torch.randn(*s, dtype=torch.bfloat16) * 0.8)(D, 4 * D) * sc), 'w_ff1b': _w((lambda *s: torch.randn(*s, dtype=torch.bfloat16) * 0.8)(4 * D, D) * sc), 'w_qkv': _w((lambda *s: torch.randn(*s, dtype=torch.bfloat16) * 0.8)(D, 3 * D) * sc), 'w_o': _w((lambda *s: torch.randn(*s, dtype=torch.bfloat16) * 1.6)(D, D) * sc), 'w_pw1': _w((lambda *s: torch.randn(*s, dtype=torch.bfloat16) * 1.6)(D, 2 * D) * sc), 'dw': _w((lambda *s: torch.randn(*s, dtype=torch.bfloat16) * 0.4)(K, D)), 'w_pw2': _w((lambda *s: torch.randn(*s, dtype=torch.bfloat16) * 0.4)(D, D) * sc), 'w_ff2a': _w((lambda *s: torch.randn(*s, dtype=torch.bfloat16) * 0.8)(D, 4 * D) * sc), 'w_ff2b': _w((lambda *s: torch.randn(*s, dtype=torch.bfloat16) * 0.8)(4 * D, D) * sc)}

def reference(x, w_ff1a, w_ff1b, w_qkv, w_o, w_pw1, dw, w_pw2, w_ff2a, w_ff2b):
    B, T, D = x.shape
    K = dw.shape[0]
    H = 4
    Dh = D // H
    h = _layernorm(x, axis=-1)
    h = _silu(h @ w_ff1a) @ w_ff1b
    x = x + 0.5 * h
    h = _layernorm(x, axis=-1)
    qkv = h @ w_qkv
    q = (lambda x, *d: x.permute(*d))(qkv[..., :D].reshape(B, T, H, Dh), 0, 2, 1, 3)
    k = (lambda x, *d: x.permute(*d))(qkv[..., D:2 * D].reshape(B, T, H, Dh), 0, 2, 1, 3)
    v = (lambda x, *d: x.permute(*d))(qkv[..., 2 * D:].reshape(B, T, H, Dh), 0, 2, 1, 3)
    scale = Dh ** (-0.5)
    scores = torch.einsum('bhqd,bhkd->bhqk', q, k) * scale
    p = _softmax(scores, axis=-1)
    att = torch.einsum('bhqk,bhkd->bhqd', p, v)
    att = (lambda x, *d: x.permute(*d))(att, 0, 2, 1, 3).reshape(B, T, D)
    x = x + att @ w_o
    h = _layernorm(x, axis=-1)
    h = h @ w_pw1
    a, b = (h[..., :D].clone(), h[..., D:].clone())
    h = a * _sigmoid(b)
    pad = K // 2
    hp = _pad(h, ((0, 0), (pad, pad), (0, 0)))
    c = torch.zeros_like(h)
    for i in range(K):
        c = c + hp[:, i:i + T, :] * dw[i][None, None, :]
    x = x + _silu(c) @ w_pw2
    h = _layernorm(x, axis=-1)
    h = _silu(h @ w_ff2a) @ w_ff2b
    x = x + 0.5 * h
    return _layernorm(x, axis=-1)
```

```asm
; @launch grid=(256,1,1) block=(512,1,1) lds=163840
.amdgcn_target "amdgcn-amd-amdhsa--gfx950"
.text
.globl standalone__conformer_family_zipformer__speech_kernel
.p2align 8
.type standalone__conformer_family_zipformer__speech_kernel,@function
standalone__conformer_family_zipformer__speech_kernel:
    s_cmp_ge_u32 s2, 256
    s_cbranch_scc1 L_end
    s_load_dwordx2 s[16:17], s[0:1], 0
    s_load_dwordx2 s[20:21], s[0:1], 8
    s_load_dwordx2 s[24:25], s[0:1], 16
    s_load_dwordx2 s[28:29], s[0:1], 24
    s_load_dwordx2 s[32:33], s[0:1], 32
    s_load_dwordx2 s[36:37], s[0:1], 40
    s_load_dwordx2 s[40:41], s[0:1], 48
    s_load_dwordx2 s[44:45], s[0:1], 56
    s_load_dwordx2 s[48:49], s[0:1], 64
    s_load_dwordx2 s[52:53], s[0:1], 72
    s_load_dwordx2 s[56:57], s[0:1], 80
    s_load_dwordx2 s[60:61], s[0:1], 88
    s_load_dwordx2 s[64:65], s[0:1], 96
    s_memrealtime s[12:13]
    s_mov_b32 s99, 0
    s_mov_b32 s18, 1024000
    s_mov_b32 s19, 0x00020000
    s_mov_b32 s22, 524288
    s_mov_b32 s23, 0x00020000
    s_mov_b32 s26, 524288
    s_mov_b32 s27, 0x00020000
    s_mov_b32 s30, 393216
    s_mov_b32 s31, 0x00020000
    s_mov_b32 s34, 131072
    s_mov_b32 s35, 0x00020000
    s_mov_b32 s38, 262144
    s_mov_b32 s39, 0x00020000
    s_mov_b32 s42, 15872
    s_mov_b32 s43, 0x00020000
    s_mov_b32 s46, 131072
    s_mov_b32 s47, 0x00020000
    s_mov_b32 s50, 524288
    s_mov_b32 s51, 0x00020000
    s_mov_b32 s54, 524288
    s_mov_b32 s55, 0x00020000
    s_mov_b32 s58, 1024000
    s_mov_b32 s59, 0x00020000
    s_mov_b32 s62, 256
    s_mov_b32 s63, 0x00020000
    s_mov_b32 s66, 33554432
    s_mov_b32 s67, 0x00020000
    v_lshrrev_b32 v7, 6, v0
    v_and_b32 v0, 63, v0
    v_readfirstlane_b32 s3, v7
    s_and_b32 s10, s2, 7
    s_lshr_b32 s9, s2, 3
    s_lshr_b32 s14, s9, 2
    s_lshl_b32 s4, s10, 3
    s_add_u32 s4, s4, s14
    s_and_b32 s5, s9, 3
    s_lshr_b32 s6, s10, 2
    s_and_b32 s7, s4, 31
    s_and_b32 s8, s10, 3
    s_lshl_b32 s11, s3, 10
    s_lshl_b32 s69, s3, 11
    s_sub_u32 s68, s11, 4096
    v_lshlrev_b32 v1, 4, v0
    v_and_b32 v5, 31, v0
    v_lshrrev_b32 v6, 5, v0
    v_bfe_u32 v3, v0, 2, 2
    v_lshl_or_b32 v3, v6, 2, v3
    v_bfe_u32 v7, v0, 4, 1
    v_and_b32 v4, 3, v0
    v_lshl_or_b32 v4, v7, 2, v4
    v_lshlrev_b32 v4, 4, v4
    s_waitcnt lgkmcnt(0)
    s_mul_i32 s14, s6, 1000
    s_lshl_b32 s15, s7, 5
    s_add_u32 s14, s14, s15
    s_lshl_b32 s70, s14, 9
    s_lshl_b32 s15, s3, 6
    s_add_u32 s70, s70, s15
    v_lshlrev_b32 v33, 9, v5
    v_lshl_or_b32 v33, v6, 4, v33
    buffer_load_dwordx4 v[40:43], v33, s[16:19], s70 offen
    buffer_load_dwordx4 v[44:47], v33, s[16:19], s70 offen offset:32
    s_lshl_b32 s98, s9, 3
    s_add_u32 s98, s98, s3
    v_mul_u32_u24 v32, 2048, v3
    v_add_u32 v32, v32, v4
    s_lshl_b32 s71, s3, 14
    s_lshl_b32 s14, s5, 9
    s_add_u32 s71, s71, s14
    s_lshr_b32 s97, s9, 2
    s_add_u32 s14, s97, 0
    s_and_b32 s14, s14, 3
    s_lshl_b32 s78, s14, 17
    s_add_u32 s78, s78, s71
    s_lshl_b32 s14, s14, 12
    v_add_u32 v240, s14, v1
    s_add_u32 m0, s11, 32768
    s_add_u32 s15, s78, 0
    buffer_load_dwordx4 v32, s[20:23], s15 offen lds
    s_add_u32 m0, s11, 40832
    s_nop 0
    buffer_load_dwordx4 v32, s[20:23], s15 offen offset:128 lds
    s_add_u32 m0, s11, 48896
    s_nop 0
    buffer_load_dwordx4 v32, s[20:23], s15 offen offset:256 lds
    s_add_u32 m0, s11, 56960
    s_nop 0
    buffer_load_dwordx4 v32, s[20:23], s15 offen offset:384 lds
    s_add_u32 s14, s97, 1
    s_and_b32 s14, s14, 3
    s_lshl_b32 s78, s14, 17
    s_add_u32 s78, s78, s71
    s_lshl_b32 s14, s14, 12
    v_add_u32 v241, s14, v1
    s_add_u32 m0, s11, 65536
    s_add_u32 s15, s78, 0
    buffer_load_dwordx4 v32, s[20:23], s15 offen lds
    s_add_u32 m0, s11, 73600
    s_nop 0
    buffer_load_dwordx4 v32, s[20:23], s15 offen offset:128 lds
    s_add_u32 m0, s11, 81664
    s_nop 0
    buffer_load_dwordx4 v32, s[20:23], s15 offen offset:256 lds
    s_add_u32 m0, s11, 89728
    s_nop 0
    buffer_load_dwordx4 v32, s[20:23], s15 offen offset:384 lds
    s_cmp_lg_u32 s3, 2
    s_cbranch_scc1 L_1
    v_lshlrev_b32 v33, 7, v0
    s_mul_i32 s15, s2, 2048
    s_mov_b64 exec, 65535
    buffer_load_dword v255, v33, s[24:27], s15 offen sc1
    s_mov_b64 exec, -1
L_1:
    s_cmp_lg_u32 s3, 3
    s_cbranch_scc1 L_2
    v_lshlrev_b32 v33, 7, v0
    s_mul_i32 s15, s2, 1536
    s_mov_b64 exec, 4095
    buffer_load_dword v255, v33, s[28:31], s15 offen sc1
    s_mov_b64 exec, -1
L_2:
    s_cmp_lg_u32 s3, 4
    s_cbranch_scc1 L_3
    v_lshlrev_b32 v33, 7, v0
    s_mul_i32 s15, s2, 512
    s_mov_b64 exec, 15
    buffer_load_dword v255, v33, s[32:35], s15 offen sc1
    s_mul_i32 s15, s2, 512
    s_mov_b64 exec, 15
    buffer_load_dword v255, v33, s[44:47], s15 offen sc1
    s_mul_i32 s15, s2, 128
    s_mov_b64 exec, 1
    buffer_load_dword v255, v33, s[40:43], s15 offen sc1
    s_mov_b64 exec, -1
L_3:
    s_cmp_lg_u32 s3, 5
    s_cbranch_scc1 L_4
    v_lshlrev_b32 v33, 7, v0
    s_mul_i32 s15, s2, 1024
    s_mov_b64 exec, 255
    buffer_load_dword v255, v33, s[36:39], s15 offen sc1
    s_mov_b64 exec, -1
L_4:
    s_cmp_lg_u32 s3, 6
    s_cbranch_scc1 L_5
    v_lshlrev_b32 v33, 7, v0
    s_mul_i32 s15, s2, 2048
    s_mov_b64 exec, 65535
    buffer_load_dword v255, v33, s[48:51], s15 offen sc1
    s_mov_b64 exec, -1
L_5:
    s_cmp_lg_u32 s3, 7
    s_cbranch_scc1 L_6
    v_lshlrev_b32 v33, 7, v0
    s_mul_i32 s15, s2, 2048
    s_mov_b64 exec, 65535
    buffer_load_dword v255, v33, s[52:55], s15 offen sc1
    s_mov_b64 exec, -1
L_6:
    s_or_b32 s12, s12, 1
    s_or_b32 s14, s2, s3
    s_cmp_lg_u32 s14, 0
    s_cbranch_scc1 L_7
    v_mov_b32 v34, s12
    v_mov_b32 v35, s13
    v_mov_b32 v36, 0
    s_mov_b64 exec, 1
    buffer_store_dwordx2 v[34:35], v36, s[60:63], 0 offen sc1
    s_mov_b64 exec, -1
L_7:
    v_bfe_u32 v2, v0, 2, 2
    v_lshlrev_b32 v2, 6, v2
    v_lshl_or_b32 v2, v6, 10, v2
    v_bfe_u32 v7, v0, 4, 1
    v_lshl_or_b32 v2, v7, 5, v2
    v_and_b32 v7, 1, v0
    v_lshl_or_b32 v2, v7, 4, v2
    v_bfe_u32 v7, v0, 1, 1
    v_lshl_or_b32 v2, v7, 3, v2
    v_and_b32 v34, 19, v5
    v_bfe_u32 v35, v5, 2, 1
    v_lshl_or_b32 v34, v35, 3, v34
    v_bfe_u32 v35, v5, 3, 1
    v_lshl_or_b32 v34, v35, 2, v34
    v_lshlrev_b32 v35, 3, v6
    v_sub_u32 v34, v34, v35
    v_and_b32 v35, 1, v34
    v_lshlrev_b32 v35, 4, v35
    v_mov_b32 v36, 0x3f80
    v_lshlrev_b32 v36, v35, v36
    v_ashrrev_i32 v34, 1, v34
    v_cmp_eq_u32 vcc, 0, v34
    s_nop 1
    v_cndmask_b32 v8, 0, v36, vcc
    v_cmp_eq_u32 vcc, 1, v34
    s_nop 1
    v_cndmask_b32 v9, 0, v36, vcc
    v_cmp_eq_u32 vcc, 2, v34
    s_nop 1
    v_cndmask_b32 v10, 0, v36, vcc
    v_cmp_eq_u32 vcc, 3, v34
    s_nop 1
    v_cndmask_b32 v11, 0, v36, vcc
    v_cmp_eq_u32 vcc, 8, v34
    s_nop 1
    v_cndmask_b32 v12, 0, v36, vcc
    v_cmp_eq_u32 vcc, 9, v34
    s_nop 1
    v_cndmask_b32 v13, 0, v36, vcc
    v_cmp_eq_u32 vcc, 10, v34
    s_nop 1
    v_cndmask_b32 v14, 0, v36, vcc
    v_cmp_eq_u32 vcc, 11, v34
    s_nop 1
    v_cndmask_b32 v15, 0, v36, vcc
    s_lshl_b32 s72, s4, 16
    s_add_u32 s72, s72, s69
    s_lshl_b32 s73, s5, 14
    s_add_u32 s73, s73, s72
    s_lshl_b32 s74, s4, 10
    s_lshr_b32 s14, s3, 1
    s_lshl_b32 s14, s14, 13
    s_and_b32 s15, s3, 1
    s_lshl_b32 s15, s15, 8
    s_add_u32 s14, s14, s15
    s_add_u32 s15, s14, 32768
    v_add_u32 v37, s15, v2
    s_add_u32 s15, s14, 98304
    v_add_u32 v38, s15, v2
    v_and_b32 v39, 3, v0
    v_lshl_add_u32 v34, v39, 7, 64
    v_add_u32 v34, 64, v34
    v_lshlrev_b32 v39, 3, v39
    v_cmp_lt_u32 vcc, 31, v0
    s_nop 1
    v_cndmask_b32 v39, v39, v34, vcc
    s_cmp_lg_u32 s3, 1
    s_nop 0
    s_cbranch_scc1 L_8
    s_lshl_b32 s14, s5, 7
    s_add_u32 s14, s14, s74
    s_add_u32 s14, s14, 128
    s_add_u32 s15, s74, 65536
    v_writelane_b32 v34, s15, 0
    s_add_u32 s15, s14, 65536
    v_writelane_b32 v34, s15, 1
    s_add_u32 s15, s74, 196608
    v_writelane_b32 v34, s15, 2
    s_add_u32 s15, s14, 196608
    v_writelane_b32 v34, s15, 3
    s_add_u32 s15, s74, 262144
    v_writelane_b32 v34, s15, 4
    s_add_u32 s15, s14, 262144
    v_writelane_b32 v34, s15, 5
    s_lshl_b32 s14, s6, 2
    s_add_u32 s14, s14, s5
    s_lshl_b32 s14, s14, 12
    s_lshl_b32 s15, s7, 7
    s_add_u32 s14, s14, s15
    s_add_u32 s14, s14, 25165824
    v_writelane_b32 v34, s14, 6
    s_lshl_b32 s14, s6, 5
    s_add_u32 s14, s14, s9
    s_lshl_b32 s14, s14, 10
    s_lshl_b32 s15, s8, 7
    s_add_u32 s14, s14, s15
    s_add_u32 s14, s14, 23134208
    v_writelane_b32 v34, s14, 7
    s_mov_b64 exec, 255
    buffer_load_dword v255, v34, s[64:67], 0 offen sc1
    s_mov_b64 exec, -1
L_8:
    s_waitcnt vmcnt(8)
    v_lshlrev_b32 v16, 16, v40
    v_and_b32 v17, 0xffff0000, v40
    v_lshlrev_b32 v18, 16, v41
    v_and_b32 v19, 0xffff0000, v41
    v_lshlrev_b32 v20, 16, v42
    v_and_b32 v21, 0xffff0000, v42
    v_lshlrev_b32 v22, 16, v43
    v_and_b32 v23, 0xffff0000, v43
    v_lshlrev_b32 v24, 16, v44
    v_and_b32 v25, 0xffff0000, v44
    v_lshlrev_b32 v26, 16, v45
    v_and_b32 v27, 0xffff0000, v45
    v_lshlrev_b32 v28, 16, v46
    v_and_b32 v29, 0xffff0000, v46
    v_lshlrev_b32 v30, 16, v47
    v_and_b32 v31, 0xffff0000, v47
    v_pk_add_f32 v[112:113], v[16:17], v[18:19]
    v_pk_mul_f32 v[114:115], v[16:17], v[16:17]
    v_pk_fma_f32 v[114:115], v[18:19], v[18:19], v[114:115]
    v_pk_add_f32 v[112:113], v[112:113], v[20:21]
    v_pk_fma_f32 v[114:115], v[20:21], v[20:21], v[114:115]
    v_pk_add_f32 v[112:113], v[112:113], v[22:23]
    v_pk_fma_f32 v[114:115], v[22:23], v[22:23], v[114:115]
    v_pk_add_f32 v[112:113], v[112:113], v[24:25]
    v_pk_fma_f32 v[114:115], v[24:25], v[24:25], v[114:115]
    v_pk_add_f32 v[112:113], v[112:113], v[26:27]
    v_pk_fma_f32 v[114:115], v[26:27], v[26:27], v[114:115]
    v_pk_add_f32 v[112:113], v[112:113], v[28:29]
    v_pk_fma_f32 v[114:115], v[28:29], v[28:29], v[114:115]
    v_pk_add_f32 v[112:113], v[112:113], v[30:31]
    v_pk_fma_f32 v[114:115], v[30:31], v[30:31], v[114:115]
    v_add_f32 v112, v112, v113
    v_add_f32 v114, v114, v115
    s_nop 1
    v_permlane32_swap_b32 v112, v114
    v_add_f32 v112, v112, v114
    s_lshl_b32 s14, s3, 2
    v_lshlrev_b32 v7, 1, v1
    v_add_u32 v113, s14, v7
    ds_write_b32 v113, v112 offset:16384
    s_add_u32 s14, s97, 2
    s_and_b32 s14, s14, 3
    s_lshl_b32 s78, s14, 17
    s_add_u32 s78, s78, s71
    s_lshl_b32 s14, s14, 12
    v_add_u32 v242, s14, v1
    s_add_u32 m0, s11, 98304
    s_add_u32 s15, s78, 0
    buffer_load_dwordx4 v32, s[20:23], s15 offen lds
    s_add_u32 m0, s11, 106368
    s_nop 0
    buffer_load_dwordx4 v32, s[20:23], s15 offen offset:128 lds
    s_add_u32 m0, s11, 114432
    s_nop 0
    buffer_load_dwordx4 v32, s[20:23], s15 offen offset:256 lds
    s_add_u32 m0, s11, 122496
    s_nop 0
    buffer_load_dwordx4 v32, s[20:23], s15 offen offset:384 lds
    s_waitcnt lgkmcnt(0)
    s_barrier
    ds_read_b128 v[112:115], v7 offset:16384
    ds_read_b128 v[116:119], v7 offset:16400
    v_add_u32 v7, s69, v1
    s_waitcnt lgkmcnt(0)
    v_pk_add_f32 v[112:113], v[112:113], v[114:115]
    v_pk_add_f32 v[116:117], v[116:117], v[118:119]
    v_pk_add_f32 v[112:113], v[112:113], v[116:117]
    v_add_f32 v112, v112, v113
    v_mul_f32 v112, 0x3b800000, v112
    v_mov_b32 v113, v112
    s_nop 1
    v_permlane32_swap_b32 v112, v113
    v_fma_f32 v113, -v112, v112, v113
    v_max_f32 v113, 0, v113
    v_add_f32 v113, 0x3727c5ac, v113
    v_rsq_f32 v114, v113
    s_nop 0
    v_mul_f32 v116, -v112, v114
    v_pk_fma_f32 v[118:119], v[16:17], v[114:115], v[116:117] op_sel_hi:[1,0,0]
    v_cvt_pk_bf16_f32 v192, v118, v119
    v_pk_fma_f32 v[112:113], v[18:19], v[114:115], v[116:117] op_sel_hi:[1,0,0]
    v_cvt_pk_bf16_f32 v193, v112, v113
    v_pk_fma_f32 v[118:119], v[20:21], v[114:115], v[116:117] op_sel_hi:[1,0,0]
    v_cvt_pk_bf16_f32 v194, v118, v119
    v_pk_fma_f32 v[112:113], v[22:23], v[114:115], v[116:117] op_sel_hi:[1,0,0]
    v_cvt_pk_bf16_f32 v195, v112, v113
    v_pk_fma_f32 v[118:119], v[24:25], v[114:115], v[116:117] op_sel_hi:[1,0,0]
    v_cvt_pk_bf16_f32 v196, v118, v119
    v_pk_fma_f32 v[112:113], v[26:27], v[114:115], v[116:117] op_sel_hi:[1,0,0]
    v_cvt_pk_bf16_f32 v197, v112, v113
    v_pk_fma_f32 v[118:119], v[28:29], v[114:115], v[116:117] op_sel_hi:[1,0,0]
    v_cvt_pk_bf16_f32 v198, v118, v119
    v_pk_fma_f32 v[112:113], v[30:31], v[114:115], v[116:117] op_sel_hi:[1,0,0]
    v_cvt_pk_bf16_f32 v199, v112, v113
    ds_write_b128 v7, v[192:195] offset:0
    ds_write_b128 v7, v[196:199] offset:1024
    s_add_u32 s14, s97, 3
    s_and_b32 s14, s14, 3
    s_lshl_b32 s78, s14, 17
    s_add_u32 s78, s78, s71
    s_lshl_b32 s14, s14, 12
    v_add_u32 v243, s14, v1
    s_add_u32 m0, s11, 131072
    s_add_u32 s15, s78, 0
    buffer_load_dwordx4 v32, s[20:23], s15 offen lds
    s_add_u32 m0, s11, 139136
    s_nop 0
    buffer_load_dwordx4 v32, s[20:23], s15 offen offset:128 lds
    s_add_u32 m0, s11, 147200
    s_nop 0
    buffer_load_dwordx4 v32, s[20:23], s15 offen offset:256 lds
    s_add_u32 m0, s11, 155264
    s_nop 0
    buffer_load_dwordx4 v32, s[20:23], s15 offen offset:384 lds
    v_lshlrev_b32 v33, 7, v0
    s_mul_i32 s15, s98, 2048
    s_mov_b64 exec, 65535
    buffer_load_dword v47, v33, s[24:27], s15 offen sc1
    s_mov_b64 exec, -1
    v_mul_u32_u24 v32, 512, v3
    v_add_u32 v32, v32, v4
    s_lshl_b32 s71, s3, 12
    s_lshl_b32 s14, s5, 17
    s_add_u32 s71, s71, s14
    s_waitcnt vmcnt(13) lgkmcnt(0)
    s_barrier
    ds_read_b64_tr_b16 v[64:65], v37 offset:0
    ds_read_b64_tr_b16 v[66:67], v37 offset:512
    ds_read_b128 v[68:71], v240 offset:0
    ds_read_b64_tr_b16 v[72:73], v37 offset:2048
    ds_read_b64_tr_b16 v[74:75], v37 offset:2560
    ds_read_b128 v[76:79], v240 offset:1024
    ds_read_b64_tr_b16 v[80:81], v37 offset:4096
    ds_read_b64_tr_b16 v[82:83], v37 offset:4608
    ds_read_b128 v[84:87], v240 offset:2048
    ds_read_b64_tr_b16 v[88:89], v37 offset:6144
    ds_read_b64_tr_b16 v[90:91], v37 offset:6656
    ds_read_b128 v[92:95], v240 offset:3072
    s_waitcnt lgkmcnt(6)
    v_mfma_f32_32x32x16_bf16 v[48:63], v[64:67], v[68:71], 0
    v_mfma_f32_32x32x16_bf16 v[48:63], v[72:75], v[76:79], v[48:63]
    s_waitcnt lgkmcnt(0)
    v_mfma_f32_32x32x16_bf16 v[48:63], v[80:83], v[84:87], v[48:63]
    v_mfma_f32_32x32x16_bf16 v[48:63], v[88:91], v[92:95], v[48:63]
    s_waitcnt vmcnt(9) lgkmcnt(0)
    s_barrier
    s_add_u32 m0, s11, 32768
    s_add_u32 s15, s71, 0
    buffer_load_dwordx4 v32, s[24:27], s15 offen lds
    s_add_u32 m0, s11, 40832
    s_nop 0
    buffer_load_dwordx4 v32, s[24:27], s15 offen offset:128 lds
    s_add_u32 m0, s11, 48896
    s_nop 0
    buffer_load_dwordx4 v32, s[24:27], s15 offen offset:256 lds
    s_add_u32 m0, s11, 56960
    s_nop 0
    buffer_load_dwordx4 v32, s[24:27], s15 offen offset:384 lds
    ds_read_b64_tr_b16 v[64:65], v37 offset:32768
    ds_read_b64_tr_b16 v[66:67], v37 offset:33280
    ds_read_b128 v[68:71], v241 offset:0
    ds_read_b64_tr_b16 v[72:73], v37 offset:34816
    ds_read_b64_tr_b16 v[74:75], v37 offset:35328
    ds_read_b128 v[76:79], v241 offset:1024
    ds_read_b64_tr_b16 v[80:81], v37 offset:36864
    ds_read_b64_tr_b16 v[82:83], v37 offset:37376
    ds_read_b128 v[84:87], v241 offset:2048
    ds_read_b64_tr_b16 v[88:89], v37 offset:38912
    ds_read_b64_tr_b16 v[90:91], v37 offset:39424
    ds_read_b128 v[92:95], v241 offset:3072
    s_waitcnt lgkmcnt(6)
    v_mfma_f32_32x32x16_bf16 v[48:63], v[64:67], v[68:71], v[48:63]
    v_mfma_f32_32x32x16_bf16 v[48:63], v[72:75], v[76:79], v[48:63]
    s_waitcnt lgkmcnt(0)
    v_mfma_f32_32x32x16_bf16 v[48:63], v[80:83], v[84:87], v[48:63]
    v_mfma_f32_32x32x16_bf16 v[48:63], v[88:91], v[92:95], v[48:63]
    s_waitcnt vmcnt(9) lgkmcnt(0)
    s_barrier
    s_add_u32 m0, s11, 65536
    s_add_u32 s15, s71, 32768
    buffer_load_dwordx4 v32, s[24:27], s15 offen lds
    s_add_u32 m0, s11, 73600
    s_nop 0
    buffer_load_dwordx4 v32, s[24:27], s15 offen offset:128 lds
    s_add_u32 m0, s11, 81664
    s_nop 0
    buffer_load_dwordx4 v32, s[24:27], s15 offen offset:256 lds
    s_add_u32 m0, s11, 89728
    s_nop 0
    buffer_load_dwordx4 v32, s[24:27], s15 offen offset:384 lds
    ds_read_b64_tr_b16 v[64:65], v38 offset:0
    ds_read_b64_tr_b16 v[66:67], v38 offset:512
    ds_read_b128 v[68:71], v242 offset:0
    ds_read_b64_tr_b16 v[72:73], v38 offset:2048
    ds_read_b64_tr_b16 v[74:75], v38 offset:2560
    ds_read_b128 v[76:79], v242 offset:1024
    ds_read_b64_tr_b16 v[80:81], v38 offset:4096
    ds_read_b64_tr_b16 v[82:83], v38 offset:4608
    ds_read_b128 v[84:87], v242 offset:2048
    ds_read_b64_tr_b16 v[88:89], v38 offset:6144
    ds_read_b64_tr_b16 v[90:91], v38 offset:6656
    ds_read_b128 v[92:95], v242 offset:3072
    s_waitcnt lgkmcnt(6)
    v_mfma_f32_32x32x16_bf16 v[48:63], v[64:67], v[68:71], v[48:63]
    v_mfma_f32_32x32x16_bf16 v[48:63], v[72:75], v[76:79], v[48:63]
    s_waitcnt lgkmcnt(0)
    v_mfma_f32_32x32x16_bf16 v[48:63], v[80:83], v[84:87], v[48:63]
    v_mfma_f32_32x32x16_bf16 v[48:63], v[88:91], v[92:95], v[48:63]
    s_waitcnt vmcnt(9) lgkmcnt(0)
    s_barrier
    s_add_u32 m0, s11, 98304
    s_add_u32 s15, s71, 65536
    buffer_load_dwordx4 v32, s[24:27], s15 offen lds
    s_add_u32 m0, s11, 106368
    s_nop 0
    buffer_load_dwordx4 v32, s[24:27], s15 offen offset:128 lds
    s_add_u32 m0, s11, 114432
    s_nop 0
    buffer_load_dwordx4 v32, s[24:27], s15 offen offset:256 lds
    s_add_u32 m0, s11, 122496
    s_nop 0
    buffer_load_dwordx4 v32, s[24:27], s15 offen offset:384 lds
    ds_read_b64_tr_b16 v[64:65], v38 offset:32768
    ds_read_b64_tr_b16 v[66:67], v38 offset:33280
    ds_read_b128 v[68:71], v243 offset:0
    ds_read_b64_tr_b16 v[72:73], v38 offset:34816
    ds_read_b64_tr_b16 v[74:75], v38 offset:35328
    ds_read_b128 v[76:79], v243 offset:1024
    ds_read_b64_tr_b16 v[80:81], v38 offset:36864
    ds_read_b64_tr_b16 v[82:83], v38 offset:37376
    ds_read_b128 v[84:87], v243 offset:2048
    ds_read_b64_tr_b16 v[88:89], v38 offset:38912
    ds_read_b64_tr_b16 v[90:91], v38 offset:39424
    ds_read_b128 v[92:95], v243 offset:3072
    s_waitcnt lgkmcnt(6)
    v_mfma_f32_32x32x16_bf16 v[48:63], v[64:67], v[68:71], v[48:63]
    v_mfma_f32_32x32x16_bf16 v[48:63], v[72:75], v[76:79], v[48:63]
    s_waitcnt lgkmcnt(0)
    v_mfma_f32_32x32x16_bf16 v[48:63], v[80:83], v[84:87], v[48:63]
    v_mfma_f32_32x32x16_bf16 v[48:63], v[88:91], v[92:95], v[48:63]
    s_waitcnt vmcnt(8)
    s_barrier
    s_add_u32 m0, s11, 131072
    s_add_u32 s15, s71, 98304
    buffer_load_dwordx4 v32, s[24:27], s15 offen lds
    s_add_u32 m0, s11, 139136
    s_nop 0
    buffer_load_dwordx4 v32, s[24:27], s15 offen offset:128 lds
    s_add_u32 m0, s11, 147200
    s_nop 0
    buffer_load_dwordx4 v32, s[24:27], s15 offen offset:256 lds
    s_add_u32 m0, s11, 155264
    s_nop 0
    buffer_load_dwordx4 v32, s[24:27], s15 offen offset:384 lds
    v_lshlrev_b32 v33, 7, v0
    s_mul_i32 s15, s98, 1536
    s_mov_b64 exec, 4095
    buffer_load_dword v47, v33, s[28:31], s15 offen sc1
    s_mov_b64 exec, -1
    s_cmp_lg_u32 s3, 0
    s_cbranch_scc1 L_9
    v_mov_b32 v36, 0
    buffer_load_dwordx2 v[34:35], v36, s[60:63], 0 offen sc1
    s_nop 0
L_9:
    ds_read_b64_tr_b16 v[128:129], v37 offset:0
    ds_read_b64_tr_b16 v[130:131], v37 offset:512
    ds_read_b64_tr_b16 v[132:133], v37 offset:2048
    ds_read_b64_tr_b16 v[134:135], v37 offset:2560
    ds_read_b64_tr_b16 v[136:137], v37 offset:4096
    ds_read_b64_tr_b16 v[138:139], v37 offset:4608
    ds_read_b64_tr_b16 v[140:141], v37 offset:6144
    ds_read_b64_tr_b16 v[142:143], v37 offset:6656
    s_mov_b32 s14, 0xbfb8aa3b
    s_mov_b32 s15, 0xbfb8aa3b
    v_pk_mul_f32 v[112:113], v[48:49], s[14:15]
    v_pk_mul_f32 v[114:115], v[50:51], s[14:15]
    v_pk_mul_f32 v[116:117], v[52:53], s[14:15]
    v_pk_mul_f32 v[118:119], v[54:55], s[14:15]
    v_pk_mul_f32 v[120:121], v[56:57], s[14:15]
    v_pk_mul_f32 v[122:123], v[58:59], s[14:15]
    v_pk_mul_f32 v[124:125], v[60:61], s[14:15]
    v_pk_mul_f32 v[126:127], v[62:63], s[14:15]
    v_exp_f32 v112, v112
    v_exp_f32 v113, v113
    v_exp_f32 v114, v114
    v_exp_f32 v115, v115
    v_exp_f32 v116, v116
    v_exp_f32 v117, v117
    v_exp_f32 v118, v118
    v_exp_f32 v119, v119
    v_exp_f32 v120, v120
    v_exp_f32 v121, v121
    v_exp_f32 v122, v122
    v_exp_f32 v123, v123
    v_exp_f32 v124, v124
    v_exp_f32 v125, v125
    v_exp_f32 v126, v126
    v_exp_f32 v127, v127
    v_pk_fma_f32 v[112:113], v[112:113], 2.0, 2.0 op_sel_hi:[1,0,0]
    v_pk_fma_f32 v[114:115], v[114:115], 2.0, 2.0 op_sel_hi:[1,0,0]
    v_pk_fma_f32 v[116:117], v[116:117], 2.0, 2.0 op_sel_hi:[1,0,0]
    v_pk_fma_f32 v[118:119], v[118:119], 2.0, 2.0 op_sel_hi:[1,0,0]
    v_pk_fma_f32 v[120:121], v[120:121], 2.0, 2.0 op_sel_hi:[1,0,0]
    v_pk_fma_f32 v[122:123], v[122:123], 2.0, 2.0 op_sel_hi:[1,0,0]
    v_pk_fma_f32 v[124:125], v[124:125], 2.0, 2.0 op_sel_hi:[1,0,0]
    v_pk_fma_f32 v[126:127], v[126:127], 2.0, 2.0 op_sel_hi:[1,0,0]
    v_rcp_f32 v112, v112
    v_rcp_f32 v113, v113
    v_rcp_f32 v114, v114
    v_rcp_f32 v115, v115
    v_rcp_f32 v116, v116
    v_rcp_f32 v117, v117
    v_rcp_f32 v118, v118
    v_rcp_f32 v119, v119
    v_rcp_f32 v120, v120
    v_rcp_f32 v121, v121
    v_rcp_f32 v122, v122
    v_rcp_f32 v123, v123
    v_rcp_f32 v124, v124
    v_rcp_f32 v125, v125
    v_rcp_f32 v126, v126
    v_rcp_f32 v127, v127
    v_pk_mul_f32 v[112:113], v[112:113], v[48:49]
    v_pk_mul_f32 v[114:115], v[114:115], v[50:51]
    v_pk_mul_f32 v[116:117], v[116:117], v[52:53]
    v_pk_mul_f32 v[118:119], v[118:119], v[54:55]
    v_pk_mul_f32 v[120:121], v[120:121], v[56:57]
    v_pk_mul_f32 v[122:123], v[122:123], v[58:59]
    v_pk_mul_f32 v[124:125], v[124:125], v[60:61]
    v_pk_mul_f32 v[126:127], v[126:127], v[62:63]
    v_cvt_pk_bf16_f32 v192, v112, v113
    v_cvt_pk_bf16_f32 v193, v114, v115
    v_cvt_pk_bf16_f32 v194, v116, v117
    v_cvt_pk_bf16_f32 v195, v118, v119
    v_cvt_pk_bf16_f32 v196, v120, v121
    v_cvt_pk_bf16_f32 v197, v122, v123
    v_cvt_pk_bf16_f32 v198, v124, v125
    v_cvt_pk_bf16_f32 v199, v126, v127
    v_add_u32 v7, s69, v1
    ds_write_b128 v7, v[192:195] offset:16384
    ds_write_b128 v7, v[196:199] offset:17408
    v_mul_u32_u24 v32, 1536, v3
    v_add_u32 v32, v32, v4
    s_mul_i32 s71, s11, 12
    s_lshl_b32 s14, s5, 7
    s_add_u32 s71, s71, s14
    s_waitcnt vmcnt(5) lgkmcnt(0)
    s_barrier
    ds_read_b128 v[64:67], v1 offset:16384
    ds_read_b128 v[68:71], v1 offset:17408
    ds_read_b128 v[72:75], v1 offset:18432
    ds_read_b128 v[76:79], v1 offset:19456
    s_add_u32 m0, s11, 32768
    s_add_u32 s15, s71, 0
    buffer_load_dwordx4 v32, s[28:31], s15 offen lds
    s_add_u32 m0, s11, 40960
    s_add_u32 s15, s71, 98304
    buffer_load_dwordx4 v32, s[28:31], s15 offen lds
    s_add_u32 m0, s11, 49152
    s_add_u32 s15, s71, 196608
    buffer_load_dwordx4 v32, s[28:31], s15 offen lds
    s_add_u32 m0, s11, 57344
    s_add_u32 s15, s71, 294912
    buffer_load_dwordx4 v32, s[28:31], s15 offen lds
    ds_read_b64_tr_b16 v[144:145], v37 offset:32768
    ds_read_b64_tr_b16 v[146:147], v37 offset:33280
    ds_read_b64_tr_b16 v[148:149], v37 offset:34816
    ds_read_b64_tr_b16 v[150:151], v37 offset:35328
    ds_read_b64_tr_b16 v[152:153], v37 offset:36864
    ds_read_b64_tr_b16 v[154:155], v37 offset:37376
    ds_read_b64_tr_b16 v[156:157], v37 offset:38912
    ds_read_b64_tr_b16 v[158:159], v37 offset:39424
    s_waitcnt lgkmcnt(8)
    v_mfma_f32_32x32x16_bf16 v[48:63], v[128:131], v[64:67], 0
    ds_read_b128 v[80:83], v1 offset:20480
    v_mfma_f32_32x32x16_bf16 v[48:63], v[132:135], v[68:71], v[48:63]
    ds_read_b128 v[84:87], v1 offset:21504
    v_mfma_f32_32x32x16_bf16 v[48:63], v[136:139], v[72:75], v[48:63]
    ds_read_b128 v[88:91], v1 offset:22528
    v_mfma_f32_32x32x16_bf16 v[48:63], v[140:143], v[76:79], v[48:63]
    ds_read_b128 v[92:95], v1 offset:23552
    s_waitcnt lgkmcnt(4)
    ds_read_b64_tr_b16 v[160:161], v38 offset:0
    ds_read_b64_tr_b16 v[162:163], v38 offset:512
    ds_read_b64_tr_b16 v[164:165], v38 offset:2048
    ds_read_b64_tr_b16 v[166:167], v38 offset:2560
    ds_read_b64_tr_b16 v[168:169], v38 offset:4096
    ds_read_b64_tr_b16 v[170:171], v38 offset:4608
    ds_read_b64_tr_b16 v[172:173], v38 offset:6144
    ds_read_b64_tr_b16 v[174:175], v38 offset:6656
    s_waitcnt lgkmcnt(8)
    v_mfma_f32_32x32x16_bf16 v[48:63], v[144:147], v[80:83], v[48:63]
    ds_read_b128 v[96:99], v1 offset:24576
    v_mfma_f32_32x32x16_bf16 v[48:63], v[148:151], v[84:87], v[48:63]
    ds_read_b128 v[100:103], v1 offset:25600
    v_mfma_f32_32x32x16_bf16 v[48:63], v[152:155], v[88:91], v[48:63]
    ds_read_b128 v[104:107], v1 offset:26624
    v_mfma_f32_32x32x16_bf16 v[48:63], v[156:159], v[92:95], v[48:63]
    ds_read_b128 v[108:111], v1 offset:27648
    s_waitcnt vmcnt(5) lgkmcnt(0)
    s_barrier
    ds_read_b64_tr_b16 v[176:177], v38 offset:32768
    ds_read_b64_tr_b16 v[178:179], v38 offset:33280
    ds_read_b64_tr_b16 v[180:181], v38 offset:34816
    ds_read_b64_tr_b16 v[182:183], v38 offset:35328
    ds_read_b64_tr_b16 v[184:185], v38 offset:36864
    ds_read_b64_tr_b16 v[186:187], v38 offset:37376
    ds_read_b64_tr_b16 v[188:189], v38 offset:38912
    ds_read_b64_tr_b16 v[190:191], v38 offset:39424
    ds_read_b128 v[112:115], v1 offset:28672
    ds_read_b128 v[116:119], v1 offset:29696
    ds_read_b128 v[120:123], v1 offset:30720
    ds_read_b128 v[124:127], v1 offset:31744
    v_mfma_f32_32x32x16_bf16 v[48:63], v[160:163], v[96:99], v[48:63]
    v_mfma_f32_32x32x16_bf16 v[48:63], v[164:167], v[100:103], v[48:63]
    v_mfma_f32_32x32x16_bf16 v[48:63], v[168:171], v[104:107], v[48:63]
    v_mfma_f32_32x32x16_bf16 v[48:63], v[172:175], v[108:111], v[48:63]
    s_waitcnt lgkmcnt(0)
    v_mfma_f32_32x32x16_bf16 v[48:63], v[176:179], v[112:115], v[48:63]
    v_mfma_f32_32x32x16_bf16 v[48:63], v[180:183], v[116:119], v[48:63]
    v_mfma_f32_32x32x16_bf16 v[48:63], v[184:187], v[120:123], v[48:63]
    v_mfma_f32_32x32x16_bf16 v[48:63], v[188:191], v[124:127], v[48:63]
    s_nop 11
    v_cvt_pk_bf16_f32 v192, v48, v49
    v_cvt_pk_bf16_f32 v193, v50, v51
    v_cvt_pk_bf16_f32 v194, v52, v53
    v_cvt_pk_bf16_f32 v195, v54, v55
    v_cvt_pk_bf16_f32 v196, v56, v57
    v_cvt_pk_bf16_f32 v197, v58, v59
    v_cvt_pk_bf16_f32 v198, v60, v61
    v_cvt_pk_bf16_f32 v199, v62, v63
    s_add_u32 s14, s73, 1048576
    buffer_store_dwordx4 v[192:195], v1, s[64:67], s14 offen sc1
    buffer_store_dwordx4 v[196:199], v1, s[64:67], s14 offen offset:1024 sc1
    v_pk_add_f32 v[16:17], v[16:17], v[48:49]
    v_pk_add_f32 v[18:19], v[18:19], v[50:51]
    v_pk_add_f32 v[20:21], v[20:21], v[52:53]
    v_pk_add_f32 v[22:23], v[22:23], v[54:55]
    v_pk_add_f32 v[24:25], v[24:25], v[56:57]
    v_pk_add_f32 v[26:27], v[26:27], v[58:59]
    v_pk_add_f32 v[28:29], v[28:29], v[60:61]
    v_pk_add_f32 v[30:31], v[30:31], v[62:63]
    s_lshl_b32 s14, s5, 3
    s_add_u32 s75, s74, s14
    s_add_u32 s75, s75, 65536
    s_add_u32 s76, s74, 65536
    s_waitcnt vmcnt(0) lgkmcnt(0)
    s_barrier
    s_cmp_lg_u32 s3, 0
    s_cbranch_scc1 L_11
    v_mov_b32 v36, 0
    s_nop 1
L_14:
    v_readfirstlane_b32 s12, v34
    v_readfirstlane_b32 s13, v35
    s_nop 0
    s_cmp_lg_u32 s12, 0
    s_nop 2
    s_cbranch_scc1 L_15
    buffer_load_dwordx2 v[34:35], v36, s[60:63], 0 offen sc1
    s_waitcnt vmcnt(0)
    s_add_u32 s99, s99, 1
    s_cmp_lt_u32 s99, 0x40000
    s_cbranch_scc1 L_14
L_15:
    s_mov_b64 exec, 1
    s_lshl_b32 s14, s5, 7
    s_add_u32 s14, s14, s76
    buffer_store_dwordx2 v[34:35], v36, s[64:67], s14 offen offset:128
    s_mov_b64 exec, -1
L_11:
    s_cmp_lt_u32 s3, 4
    s_cbranch_scc1 L_10
    s_mul_i32 s71, s68, 12
    s_lshl_b32 s14, s5, 7
    s_add_u32 s71, s71, s14
    s_add_u32 m0, s68, 65024
    s_add_u32 s15, s71, 0
    buffer_load_dwordx4 v32, s[28:31], s15 offen offset:512 lds
    s_add_u32 m0, s68, 97280
    s_nop 0
    buffer_load_dwordx4 v32, s[28:31], s15 offen offset:1024 lds
    s_add_u32 m0, s68, 69120
    s_add_u32 s15, s71, 49152
    buffer_load_dwordx4 v32, s[28:31], s15 offen offset:512 lds
    s_add_u32 m0, s68, 101376
    s_nop 0
    buffer_load_dwordx4 v32, s[28:31], s15 offen offset:1024 lds
    s_add_u32 m0, s68, 73216
    s_add_u32 s15, s71, 98304
    buffer_load_dwordx4 v32, s[28:31], s15 offen offset:512 lds
    s_add_u32 m0, s68, 105472
    s_nop 0
    buffer_load_dwordx4 v32, s[28:31], s15 offen offset:1024 lds
    s_add_u32 m0, s68, 77312
    s_add_u32 s15, s71, 147456
    buffer_load_dwordx4 v32, s[28:31], s15 offen offset:512 lds
    s_add_u32 m0, s68, 109568
    s_nop 0
    buffer_load_dwordx4 v32, s[28:31], s15 offen offset:1024 lds
    s_add_u32 m0, s68, 81408
    s_add_u32 s15, s71, 196608
    buffer_load_dwordx4 v32, s[28:31], s15 offen offset:512 lds
    s_add_u32 m0, s68, 113664
    s_nop 0
    buffer_load_dwordx4 v32, s[28:31], s15 offen offset:1024 lds
    s_add_u32 m0, s68, 85504
    s_add_u32 s15, s71, 245760
    buffer_load_dwordx4 v32, s[28:31], s15 offen offset:512 lds
    s_add_u32 m0, s68, 117760
    s_nop 0
    buffer_load_dwordx4 v32, s[28:31], s15 offen offset:1024 lds
    s_add_u32 m0, s68, 89600
    s_add_u32 s15, s71, 294912
    buffer_load_dwordx4 v32, s[28:31], s15 offen offset:512 lds
    s_add_u32 m0, s68, 121856
    s_nop 0
    buffer_load_dwordx4 v32, s[28:31], s15 offen offset:1024 lds
    s_add_u32 m0, s68, 93696
    s_add_u32 s15, s71, 344064
    buffer_load_dwordx4 v32, s[28:31], s15 offen offset:512 lds
    s_add_u32 m0, s68, 125952
    s_nop 0
    buffer_load_dwordx4 v32, s[28:31], s15 offen offset:1024 lds
    s_branch L_13
L_10:
    s_cmp_eq_u32 s3, 0
    s_cbranch_scc1 L_16
    s_branch L_13
L_16:
    s_mov_b32 s14, 0
    s_mov_b32 exec_lo, 0
    buffer_load_dwordx2 v[120:121], v39, s[64:67], s76 offen sc1
    buffer_load_dwordx2 v[122:123], v39, s[64:67], s76 offen sc1
    s_mov_b64 exec, 1
    buffer_store_dwordx2 v[34:35], v36, s[64:67], s75 offen sc1
    s_mov_b32 exec_lo, 0
    s_mov_b32 exec_hi, -1
    s_waitcnt vmcnt(1)
    v_cmp_ne_u64 vcc, s[12:13], v[122:123]
    s_nop 4
    s_cbranch_vccz L_13
L_17:
    buffer_load_dwordx2 v[120:121], v39, s[64:67], s76 offen sc1
    s_waitcnt vmcnt(0)
    v_cmp_ne_u64 vcc, s[12:13], v[120:121]
    s_nop 4
    s_cbranch_vccz L_13
    s_add_u32 s14, s14, 1
    s_cmp_lt_u32 s14, 8
    s_cbranch_scc1 L_17
    s_mov_b64 exec, -1
    buffer_load_dwordx2 v[120:121], v39, s[64:67], s76 offen sc1
    s_sleep 2
    buffer_load_dwordx2 v[122:123], v39, s[64:67], s76 offen sc1
    s_sleep 2
    buffer_load_dwordx2 v[124:125], v39, s[64:67], s76 offen sc1
    s_sleep 2
L_12:
    buffer_load_dwordx2 v[126:127], v39, s[64:67], s76 offen sc1
    s_waitcnt vmcnt(3)
    v_cmp_ne_u64 vcc, s[12:13], v[120:121]
    s_nop 1
    s_and_b32 s14, vcc_lo, vcc_hi
    s_nop 1
    s_cbranch_scc0 L_13
    buffer_load_dwordx2 v[120:121], v39, s[64:67], s76 offen sc1
    s_waitcnt vmcnt(3)
    v_cmp_ne_u64 vcc, s[12:13], v[122:123]
    s_nop 1
    s_and_b32 s14, vcc_lo, vcc_hi
    s_nop 1
    s_cbranch_scc0 L_13
    buffer_load_dwordx2 v[122:123], v39, s[64:67], s76 offen sc1
    s_waitcnt vmcnt(3)
    v_cmp_ne_u64 vcc, s[12:13], v[124:125]
    s_nop 1
    s_and_b32 s14, vcc_lo, vcc_hi
    s_nop 1
    s_cbranch_scc0 L_13
    buffer_load_dwordx2 v[124:125], v39, s[64:67], s76 offen sc1
    s_waitcnt vmcnt(3)
    v_cmp_ne_u64 vcc, s[12:13], v[126:127]
    s_nop 1
    s_and_b32 s14, vcc_lo, vcc_hi
    s_nop 1
    s_cbranch_scc0 L_13
    s_add_u32 s99, s99, 1
    s_cmp_lt_u32 s99, 0x10000
    s_cbranch_scc1 L_12
L_13:
    s_mov_b64 exec, -1
    s_barrier
    s_add_u32 s14, s5, 1
    s_and_b32 s14, s14, 3
    s_lshl_b32 s14, s14, 14
    s_add_u32 s14, s14, s72
    s_add_u32 s14, s14, 1048576
    buffer_load_dwordx4 v[64:67], v1, s[64:67], s14 offen sc1
    buffer_load_dwordx4 v[68:71], v1, s[64:67], s14 offen offset:1024 sc1
    s_add_u32 s14, s5, 2
    s_and_b32 s14, s14, 3
    s_lshl_b32 s14, s14, 14
    s_add_u32 s14, s14, s72
    s_add_u32 s14, s14, 1048576
    buffer_load_dwordx4 v[72:75], v1, s[64:67], s14 offen sc1
    buffer_load_dwordx4 v[76:79], v1, s[64:67], s14 offen offset:1024 sc1
    s_add_u32 s14, s5, 3
    s_and_b32 s14, s14, 3
    s_lshl_b32 s14, s14, 14
    s_add_u32 s14, s14, s72
    s_add_u32 s14, s14, 1048576
    buffer_load_dwordx4 v[80:83], v1, s[64:67], s14 offen sc1
    buffer_load_dwordx4 v[84:87], v1, s[64:67], s14 offen offset:1024 sc1
    s_waitcnt vmcnt(4)
    v_mfma_f32_32x32x16_bf16 v[16:31], v[8:11], v[64:67], v[16:31]
    v_mfma_f32_32x32x16_bf16 v[16:31], v[12:15], v[68:71], v[16:31]
    s_waitcnt vmcnt(2)
    v_mfma_f32_32x32x16_bf16 v[16:31], v[8:11], v[72:75], v[16:31]
    v_mfma_f32_32x32x16_bf16 v[16:31], v[12:15], v[76:79], v[16:31]
    s_waitcnt vmcnt(0)
    v_mfma_f32_32x32x16_bf16 v[16:31], v[8:11], v[80:83], v[16:31]
    v_mfma_f32_32x32x16_bf16 v[16:31], v[12:15], v[84:87], v[16:31]
    s_nop 11
    v_pk_add_f32 v[112:113], v[16:17], v[18:19]
    v_pk_mul_f32 v[114:115], v[16:17], v[16:17]
    v_pk_fma_f32 v[114:115], v[18:19], v[18:19], v[114:115]
    v_pk_add_f32 v[112:113], v[112:113], v[20:21]
    v_pk_fma_f32 v[114:115], v[20:21], v[20:21], v[114:115]
    v_pk_add_f32 v[112:113], v[112:113], v[22:23]
    v_pk_fma_f32 v[114:115], v[22:23], v[22:23], v[114:115]
    v_pk_add_f32 v[112:113], v[112:113], v[24:25]
    v_pk_fma_f32 v[114:115], v[24:25], v[24:25], v[114:115]
    v_pk_add_f32 v[112:113], v[112:113], v[26:27]
    v_pk_fma_f32 v[114:115], v[26:27], v[26:27], v[114:115]
    v_pk_add_f32 v[112:113], v[112:113], v[28:29]
    v_pk_fma_f32 v[114:115], v[28:29], v[28:29], v[114:115]
    v_pk_add_f32 v[112:113], v[112:113], v[30:31]
    v_pk_fma_f32 v[114:115], v[30:31], v[30:31], v[114:115]
    v_add_f32 v112, v112, v113
    v_add_f32 v114, v114, v115
    s_nop 1
    v_permlane32_swap_b32 v112, v114
    v_add_f32 v112, v112, v114
    s_lshl_b32 s14, s3, 2
    v_lshlrev_b32 v7, 1, v1
    v_add_u32 v113, s14, v7
    ds_write_b32 v113, v112 offset:16384
    s_waitcnt lgkmcnt(0)
    s_barrier
    ds_read_b128 v[112:115], v7 offset:16384
    ds_read_b128 v[116:119], v7 offset:16400
    v_add_u32 v7, s69, v1
    s_waitcnt lgkmcnt(0)
    v_pk_add_f32 v[112:113], v[112:113], v[114:115]
    v_pk_add_f32 v[116:117], v[116:117], v[118:119]
    v_pk_add_f32 v[112:113], v[112:113], v[116:117]
    v_add_f32 v112, v112, v113
    v_mul_f32 v112, 0x3b800000, v112
    v_mov_b32 v113, v112
    s_nop 1
    v_permlane32_swap_b32 v112, v113
    v_fma_f32 v113, -v112, v112, v113
    v_max_f32 v113, 0, v113
    v_add_f32 v113, 0x3727c5ac, v113
    v_rsq_f32 v114, v113
    s_nop 0
    v_mul_f32 v116, -v112, v114
    v_pk_fma_f32 v[118:119], v[16:17], v[114:115], v[116:117] op_sel_hi:[1,0,0]
    v_cvt_pk_bf16_f32 v192, v118, v119
    v_pk_fma_f32 v[112:113], v[18:19], v[114:115], v[116:117] op_sel_hi:[1,0,0]
    v_cvt_pk_bf16_f32 v193, v112, v113
    v_pk_fma_f32 v[118:119], v[20:21], v[114:115], v[116:117] op_sel_hi:[1,0,0]
    v_cvt_pk_bf16_f32 v194, v118, v119
    v_pk_fma_f32 v[112:113], v[22:23], v[114:115], v[116:117] op_sel_hi:[1,0,0]
    v_cvt_pk_bf16_f32 v195, v112, v113
    v_pk_fma_f32 v[118:119], v[24:25], v[114:115], v[116:117] op_sel_hi:[1,0,0]
    v_cvt_pk_bf16_f32 v196, v118, v119
    v_pk_fma_f32 v[112:113], v[26:27], v[114:115], v[116:117] op_sel_hi:[1,0,0]
    v_cvt_pk_bf16_f32 v197, v112, v113
    v_pk_fma_f32 v[118:119], v[28:29], v[114:115], v[116:117] op_sel_hi:[1,0,0]
    v_cvt_pk_bf16_f32 v198, v118, v119
    v_pk_fma_f32 v[112:113], v[30:31], v[114:115], v[116:117] op_sel_hi:[1,0,0]
    v_cvt_pk_bf16_f32 v199, v112, v113
    ds_write_b128 v7, v[192:195] offset:0
    ds_write_b128 v7, v[196:199] offset:1024
    s_cmp_lg_u32 s5, 0
    s_cbranch_scc1 L_18
    v_cvt_pk_bf16_f32 v200, v16, v17
    v_cvt_pk_bf16_f32 v201, v18, v19
    v_cvt_pk_bf16_f32 v202, v20, v21
    v_cvt_pk_bf16_f32 v203, v22, v23
    v_cvt_pk_bf16_f32 v204, v24, v25
    v_cvt_pk_bf16_f32 v205, v26, v27
    v_cvt_pk_bf16_f32 v206, v28, v29
    v_cvt_pk_bf16_f32 v207, v30, v31
    s_lshl_b32 s14, s4, 14
    s_add_u32 s14, s14, s69
    s_add_u32 s14, s14, 17825792
    buffer_store_dwordx4 v[200:203], v1, s[64:67], s14 offen sc1
    buffer_store_dwordx4 v[204:207], v1, s[64:67], s14 offen offset:1024 sc1
    s_nop 1
L_18:
    s_lshr_b32 s14, s3, 1
    s_lshl_b32 s14, s14, 15
    s_and_b32 s15, s3, 1
    s_lshl_b32 s15, s15, 8
    s_add_u32 s14, s14, s15
    s_add_u32 s14, s14, 32768
    v_add_u32 v32, s14, v2
    s_waitcnt lgkmcnt(0)
    s_barrier
    s_cmp_ge_u32 s3, 6
    s_cbranch_scc1 L_22
    s_cmp_ge_u32 s3, 4
    s_cbranch_scc1 L_19
    ds_read_b64_tr_b16 v[64:65], v32 offset:0
    ds_read_b64_tr_b16 v[66:67], v32 offset:512
    ds_read_b128 v[68:71], v1 offset:0
    ds_read_b64_tr_b16 v[72:73], v32 offset:2048
    ds_read_b64_tr_b16 v[74:75], v32 offset:2560
    ds_read_b128 v[76:79], v1 offset:1024
    ds_read_b64_tr_b16 v[80:81], v32 offset:4096
    ds_read_b64_tr_b16 v[82:83], v32 offset:4608
    ds_read_b128 v[84:87], v1 offset:2048
    ds_read_b64_tr_b16 v[88:89], v32 offset:6144
    ds_read_b64_tr_b16 v[90:91], v32 offset:6656
    ds_read_b128 v[92:95], v1 offset:3072
    s_waitcnt lgkmcnt(6)
    v_mfma_f32_32x32x16_bf16 v[48:63], v[64:67], v[68:71], 0
    ds_read_b64_tr_b16 v[96:97], v32 offset:8192
    ds_read_b64_tr_b16 v[98:99], v32 offset:8704
    ds_read_b128 v[100:103], v1 offset:4096
    ds_read_b64_tr_b16 v[104:105], v32 offset:10240
    ds_read_b64_tr_b16 v[106:107], v32 offset:10752
    ds_read_b128 v[108:111], v1 offset:5120
    v_mfma_f32_32x32x16_bf16 v[48:63], v[72:75], v[76:79], v[48:63]
    s_waitcnt lgkmcnt(6)
    v_mfma_f32_32x32x16_bf16 v[48:63], v[80:83], v[84:87], v[48:63]
    ds_read_b64_tr_b16 v[64:65], v32 offset:12288
    ds_read_b64_tr_b16 v[66:67], v32 offset:12800
    ds_read_b128 v[68:71], v1 offset:6144
    ds_read_b64_tr_b16 v[72:73], v32 offset:14336
    ds_read_b64_tr_b16 v[74:75], v32 offset:14848
    ds_read_b128 v[76:79], v1 offset:7168
    v_mfma_f32_32x32x16_bf16 v[48:63], v[88:91], v[92:95], v[48:63]
    s_waitcnt lgkmcnt(6)
    v_mfma_f32_32x32x16_bf16 v[48:63], v[96:99], v[100:103], v[48:63]
    ds_read_b64_tr_b16 v[80:81], v32 offset:16384
    ds_read_b64_tr_b16 v[82:83], v32 offset:16896
    ds_read_b128 v[84:87], v1 offset:8192
    ds_read_b64_tr_b16 v[88:89], v32 offset:18432
    ds_read_b64_tr_b16 v[90:91], v32 offset:18944
    ds_read_b128 v[92:95], v1 offset:9216
    v_mfma_f32_32x32x16_bf16 v[48:63], v[104:107], v[108:111], v[48:63]
    s_waitcnt lgkmcnt(6)
    v_mfma_f32_32x32x16_bf16 v[48:63], v[64:67], v[68:71], v[48:63]
    ds_read_b64_tr_b16 v[96:97], v32 offset:20480
    ds_read_b64_tr_b16 v[98:99], v32 offset:20992
    ds_read_b128 v[100:103], v1 offset:10240
    ds_read_b64_tr_b16 v[104:105], v32 offset:22528
    ds_read_b64_tr_b16 v[106:107], v32 offset:23040
    ds_read_b128 v[108:111], v1 offset:11264
    v_mfma_f32_32x32x16_bf16 v[48:63], v[72:75], v[76:79], v[48:63]
    s_waitcnt lgkmcnt(6)
    v_mfma_f32_32x32x16_bf16 v[48:63], v[80:83], v[84:87], v[48:63]
    ds_read_b64_tr_b16 v[64:65], v32 offset:24576
    ds_read_b64_tr_b16 v[66:67], v32 offset:25088
    ds_read_b128 v[68:71], v1 offset:12288
    ds_read_b64_tr_b16 v[72:73], v32 offset:26624
    ds_read_b64_tr_b16 v[74:75], v32 offset:27136
    ds_read_b128 v[76:79], v1 offset:13312
    v_mfma_f32_32x32x16_bf16 v[48:63], v[88:91], v[92:95], v[48:63]
    s_waitcnt lgkmcnt(6)
    v_mfma_f32_32x32x16_bf16 v[48:63], v[96:99], v[100:103], v[48:63]
    ds_read_b64_tr_b16 v[80:81], v32 offset:28672
    ds_read_b64_tr_b16 v[82:83], v32 offset:29184
    ds_read_b128 v[84:87], v1 offset:14336
    ds_read_b64_tr_b16 v[88:89], v32 offset:30720
    ds_read_b64_tr_b16 v[90:91], v32 offset:31232
    ds_read_b128 v[92:95], v1 offset:15360
    v_mfma_f32_32x32x16_bf16 v[48:63], v[104:107], v[108:111], v[48:63]
    s_waitcnt lgkmcnt(6)
    v_mfma_f32_32x32x16_bf16 v[48:63], v[64:67], v[68:71], v[48:63]
    v_mfma_f32_32x32x16_bf16 v[48:63], v[72:75], v[76:79], v[48:63]
    s_waitcnt lgkmcnt(0)
    v_mfma_f32_32x32x16_bf16 v[48:63], v[80:83], v[84:87], v[48:63]
    v_mfma_f32_32x32x16_bf16 v[48:63], v[88:91], v[92:95], v[48:63]
    s_nop 11
    s_branch L_20
L_19:
    ds_read_b64_tr_b16 v[64:65], v32 offset:0
    ds_read_b64_tr_b16 v[66:67], v32 offset:512
    ds_read_b128 v[68:71], v1 offset:0
    ds_read_b64_tr_b16 v[72:73], v32 offset:2048
    ds_read_b64_tr_b16 v[74:75], v32 offset:2560
    ds_read_b128 v[76:79], v1 offset:1024
    ds_read_b64_tr_b16 v[80:81], v32 offset:4096
    ds_read_b64_tr_b16 v[82:83], v32 offset:4608
    ds_read_b128 v[84:87], v1 offset:2048
    ds_read_b64_tr_b16 v[88:89], v32 offset:6144
    ds_read_b64_tr_b16 v[90:91], v32 offset:6656
    ds_read_b128 v[92:95], v1 offset:3072
    s_waitcnt lgkmcnt(6)
    v_mfma_f32_32x32x16_bf16 v[48:63], v[68:71], v[64:67], 0
    ds_read_b64_tr_b16 v[96:97], v32 offset:8192
    ds_read_b64_tr_b16 v[98:99], v32 offset:8704
    ds_read_b128 v[100:103], v1 offset:4096
    ds_read_b64_tr_b16 v[104:105], v32 offset:10240
    ds_read_b64_tr_b16 v[106:107], v32 offset:10752
    ds_read_b128 v[108:111], v1 offset:5120
    v_mfma_f32_32x32x16_bf16 v[48:63], v[76:79], v[72:75], v[48:63]
    s_waitcnt lgkmcnt(6)
    v_mfma_f32_32x32x16_bf16 v[48:63], v[84:87], v[80:83], v[48:63]
    ds_read_b64_tr_b16 v[64:65], v32 offset:12288
    ds_read_b64_tr_b16 v[66:67], v32 offset:12800
    ds_read_b128 v[68:71], v1 offset:6144
    ds_read_b64_tr_b16 v[72:73], v32 offset:14336
    ds_read_b64_tr_b16 v[74:75], v32 offset:14848
    ds_read_b128 v[76:79], v1 offset:7168
    v_mfma_f32_32x32x16_bf16 v[48:63], v[92:95], v[88:91], v[48:63]
    s_waitcnt lgkmcnt(6)
    v_mfma_f32_32x32x16_bf16 v[48:63], v[100:103], v[96:99], v[48:63]
    ds_read_b64_tr_b16 v[80:81], v32 offset:16384
    ds_read_b64_tr_b16 v[82:83], v32 offset:16896
    ds_read_b128 v[84:87], v1 offset:8192
    ds_read_b64_tr_b16 v[88:89], v32 offset:18432
    ds_read_b64_tr_b16 v[90:91], v32 offset:18944
    ds_read_b128 v[92:95], v1 offset:9216
    v_mfma_f32_32x32x16_bf16 v[48:63], v[108:111], v[104:107], v[48:63]
    s_waitcnt lgkmcnt(6)
    v_mfma_f32_32x32x16_bf16 v[48:63], v[68:71], v[64:67], v[48:63]
    ds_read_b64_tr_b16 v[96:97], v32 offset:20480
    ds_read_b64_tr_b16 v[98:99], v32 offset:20992
    ds_read_b128 v[100:103], v1 offset:10240
    ds_read_b64_tr_b16 v[104:105], v32 offset:22528
    ds_read_b64_tr_b16 v[106:107], v32 offset:23040
    ds_read_b128 v[108:111], v1 offset:11264
    v_mfma_f32_32x32x16_bf16 v[48:63], v[76:79], v[72:75], v[48:63]
    s_waitcnt lgkmcnt(6)
    v_mfma_f32_32x32x16_bf16 v[48:63], v[84:87], v[80:83], v[48:63]
    ds_read_b64_tr_b16 v[64:65], v32 offset:24576
    ds_read_b64_tr_b16 v[66:67], v32 offset:25088
    ds_read_b128 v[68:71], v1 offset:12288
    ds_read_b64_tr_b16 v[72:73], v32 offset:26624
    ds_read_b64_tr_b16 v[74:75], v32 offset:27136
    ds_read_b128 v[76:79], v1 offset:13312
    v_mfma_f32_32x32x16_bf16 v[48:63], v[92:95], v[88:91], v[48:63]
    s_waitcnt lgkmcnt(6)
    v_mfma_f32_32x32x16_bf16 v[48:63], v[100:103], v[96:99], v[48:63]
    ds_read_b64_tr_b16 v[80:81], v32 offset:28672
    ds_read_b64_tr_b16 v[82:83], v32 offset:29184
    ds_read_b128 v[84:87], v1 offset:14336
    ds_read_b64_tr_b16 v[88:89], v32 offset:30720
    ds_read_b64_tr_b16 v[90:91], v32 offset:31232
    ds_read_b128 v[92:95], v1 offset:15360
    v_mfma_f32_32x32x16_bf16 v[48:63], v[108:111], v[104:107], v[48:63]
    s_waitcnt lgkmcnt(6)
    v_mfma_f32_32x32x16_bf16 v[48:63], v[68:71], v[64:67], v[48:63]
    v_mfma_f32_32x32x16_bf16 v[48:63], v[76:79], v[72:75], v[48:63]
    s_waitcnt lgkmcnt(0)
    v_mfma_f32_32x32x16_bf16 v[48:63], v[84:87], v[80:83], v[48:63]
    v_mfma_f32_32x32x16_bf16 v[48:63], v[92:95], v[88:91], v[48:63]
    s_nop 11
L_20:
    v_cvt_pk_bf16_f32 v192, v48, v49
    v_cvt_pk_bf16_f32 v193, v50, v51
    v_cvt_pk_bf16_f32 v194, v52, v53
    v_cvt_pk_bf16_f32 v195, v54, v55
    v_cvt_pk_bf16_f32 v196, v56, v57
    v_cvt_pk_bf16_f32 v197, v58, v59
    v_cvt_pk_bf16_f32 v198, v60, v61
    v_cvt_pk_bf16_f32 v199, v62, v63
    s_lshl_b32 s14, s6, 2
    s_add_u32 s14, s14, s5
    s_lshl_b32 s14, s14, 5
    s_add_u32 s14, s14, s7
    s_lshl_b32 s14, s14, 12
    s_lshr_b32 s15, s3, 1
    s_lshl_b32 s15, s15, 20
    s_add_u32 s14, s14, s15
    s_and_b32 s15, s3, 1
    s_lshl_b32 s15, s15, 11
    s_add_u32 s14, s14, s15
    s_add_u32 s14, s14, 18874368
    buffer_store_dwordx4 v[192:195], v1, s[64:67], s14 offen sc1
    buffer_store_dwordx4 v[196:199], v1, s[64:67], s14 offen offset:1024 sc1
    s_nop 1
L_22:
L_21:
    s_lshl_b32 s14, s6, 2
    s_add_u32 s14, s14, s5
    s_lshl_b32 s14, s14, 12
    s_lshl_b32 s15, s7, 7
    s_add_u32 s75, s14, s15
    s_add_u32 s75, s75, 25165824
    s_lshl_b32 s76, s10, 12
    s_add_u32 s76, s76, 25165824
    v_lshlrev_b32 v112, 7, v5
    s_waitcnt vmcnt(0) lgkmcnt(0)
    s_barrier
    s_cmp_lg_u32 s3, 0
    s_cbranch_scc1 L_24
    v_mov_b32 v36, 0
    v_mov_b32 v34, s12
    v_mov_b32 v35, s13
    s_mov_b64 exec, 1
    buffer_store_dwordx2 v[34:35], v36, s[64:67], s75 offen sc1
    s_mov_b64 exec, -1
L_24:
    s_cmp_lt_u32 s3, 4
    s_cbranch_scc1 L_23
    v_mul_u32_u24 v32, 512, v3
    v_add_u32 v32, v32, v4
    s_lshl_b32 s71, s68, 2
    s_lshl_b32 s14, s8, 15
    s_add_u32 s71, s71, s14
    s_add_u32 m0, s68, 131072
    s_add_u32 s15, s71, 0
    buffer_load_dwordx4 v32, s[32:35], s15 offen lds
    s_add_u32 m0, s68, 139136
    s_nop 0
    buffer_load_dwordx4 v32, s[32:35], s15 offen offset:128 lds
    s_add_u32 m0, s68, 147200
    s_nop 0
    buffer_load_dwordx4 v32, s[32:35], s15 offen offset:256 lds
    s_add_u32 m0, s68, 155264
    s_nop 0
    buffer_load_dwordx4 v32, s[32:35], s15 offen offset:384 lds
    s_add_u32 m0, s68, 135168
    s_add_u32 s15, s71, 16384
    buffer_load_dwordx4 v32, s[32:35], s15 offen lds
    s_add_u32 m0, s68, 143232
    s_nop 0
    buffer_load_dwordx4 v32, s[32:35], s15 offen offset:128 lds
    s_add_u32 m0, s68, 151296
    s_nop 0
    buffer_load_dwordx4 v32, s[32:35], s15 offen offset:256 lds
    s_add_u32 m0, s68, 159360
    s_nop 0
    buffer_load_dwordx4 v32, s[32:35], s15 offen offset:384 lds
    v_lshrrev_b32 v32, 3, v0
    v_lshlrev_b32 v32, 9, v32
    v_and_b32 v33, 7, v0
    v_lshl_add_u32 v32, v33, 4, v32
    s_lshl_b32 s71, s68, 2
    s_lshl_b32 s14, s5, 7
    s_add_u32 s71, s71, s14
    s_add_u32 m0, s68, 61440
    s_add_u32 s15, s71, 0
    buffer_load_dwordx4 v32, s[40:43], s15 offen lds
    s_branch L_26
L_23:
    s_cmp_eq_u32 s3, 0
    s_cbranch_scc1 L_27
    s_branch L_26
L_27:
    buffer_load_dwordx2 v[120:121], v112, s[64:67], s76 offen sc1
    s_sleep 2
    buffer_load_dwordx2 v[122:123], v112, s[64:67], s76 offen sc1
    s_sleep 2
    buffer_load_dwordx2 v[124:125], v112, s[64:67], s76 offen sc1
    s_sleep 2
L_25:
    buffer_load_dwordx2 v[126:127], v112, s[64:67], s76 offen sc1
    s_waitcnt vmcnt(3)
    v_cmp_ne_u64 vcc, s[12:13], v[120:121]
    s_nop 4
    s_cbranch_vccz L_26
    s_sleep 1
    buffer_load_dwordx2 v[120:121], v112, s[64:67], s76 offen sc1
    s_waitcnt vmcnt(3)
    v_cmp_ne_u64 vcc, s[12:13], v[122:123]
    s_nop 4
    s_cbranch_vccz L_26
    s_sleep 1
    buffer_load_dwordx2 v[122:123], v112, s[64:67], s76 offen sc1
    s_waitcnt vmcnt(3)
    v_cmp_ne_u64 vcc, s[12:13], v[124:125]
    s_nop 4
    s_cbranch_vccz L_26
    s_sleep 1
    buffer_load_dwordx2 v[124:125], v112, s[64:67], s76 offen sc1
    s_waitcnt vmcnt(3)
    v_cmp_ne_u64 vcc, s[12:13], v[126:127]
    s_nop 4
    s_cbranch_vccz L_26
    s_sleep 1
    s_add_u32 s99, s99, 1
    s_cmp_lt_u32 s99, 0x10000
    s_cbranch_scc1 L_25
L_26:
    s_mov_b64 exec, -1
    s_barrier
    s_lshl_b32 s14, s10, 17
    s_lshl_b32 s15, s9, 12
    s_add_u32 s15, s15, s14
    s_add_u32 s15, s15, 18874368
    s_add_u32 s77, s3, s9
    s_and_b32 s77, s77, 7
    s_lshl_b32 s71, s77, 14
    s_add_u32 s71, s71, s14
    s_cmp_ge_u32 s3, 4
    s_cbranch_scc1 L_28
    s_add_u32 s15, s15, s11
    s_add_u32 m0, s11, 40960
    s_nop 0
    buffer_load_dwordx4 v1, s[64:67], s15 offen sc1 lds
    s_add_u32 s15, s71, 19922944
    buffer_load_dwordx4 v[48:51], v1, s[64:67], s15 offen offset:0 sc1
    buffer_load_dwordx4 v[52:55], v1, s[64:67], s15 offen offset:1024 sc1
    buffer_load_dwordx4 v[56:59], v1, s[64:67], s15 offen offset:2048 sc1
    buffer_load_dwordx4 v[60:63], v1, s[64:67], s15 offen offset:3072 sc1
    s_add_u32 s15, s71, 19927040
    buffer_load_dwordx4 v[64:67], v1, s[64:67], s15 offen offset:0 sc1
    buffer_load_dwordx4 v[68:71], v1, s[64:67], s15 offen offset:1024 sc1
    buffer_load_dwordx4 v[72:75], v1, s[64:67], s15 offen offset:2048 sc1
    buffer_load_dwordx4 v[76:79], v1, s[64:67], s15 offen offset:3072 sc1
    s_add_u32 s15, s71, 19931136
    buffer_load_dwordx4 v[80:83], v1, s[64:67], s15 offen offset:0 sc1
    buffer_load_dwordx4 v[84:87], v1, s[64:67], s15 offen offset:1024 sc1
    buffer_load_dwordx4 v[88:91], v1, s[64:67], s15 offen offset:2048 sc1
    buffer_load_dwordx4 v[92:95], v1, s[64:67], s15 offen offset:3072 sc1
    s_add_u32 s15, s71, 19935232
    buffer_load_dwordx4 v[96:99], v1, s[64:67], s15 offen offset:0 sc1
    buffer_load_dwordx4 v[100:103], v1, s[64:67], s15 offen offset:1024 sc1
    buffer_load_dwordx4 v[104:107], v1, s[64:67], s15 offen offset:2048 sc1
    buffer_load_dwordx4 v[108:111], v1, s[64:67], s15 offen offset:3072 sc1
    s_waitcnt vmcnt(16)
L_28:
    s_barrier
    ds_read_b128 v[240:243], v1 offset:40960
    ds_read_b128 v[244:247], v1 offset:41984
    ds_read_b128 v[248:251], v1 offset:43008
    ds_read_b128 v[252:255], v1 offset:44032
    s_cmp_lt_u32 s3, 4
    s_cbranch_scc1 L_29
    s_add_u32 s15, s71, 19922944
    buffer_load_dwordx4 v[48:51], v1, s[64:67], s15 offen offset:0 sc1
    buffer_load_dwordx4 v[52:55], v1, s[64:67], s15 offen offset:1024 sc1
    buffer_load_dwordx4 v[56:59], v1, s[64:67], s15 offen offset:2048 sc1
    buffer_load_dwordx4 v[60:63], v1, s[64:67], s15 offen offset:3072 sc1
    s_add_u32 s15, s71, 19927040
    buffer_load_dwordx4 v[64:67], v1, s[64:67], s15 offen offset:0 sc1
    buffer_load_dwordx4 v[68:71], v1, s[64:67], s15 offen offset:1024 sc1
    buffer_load_dwordx4 v[72:75], v1, s[64:67], s15 offen offset:2048 sc1
    buffer_load_dwordx4 v[76:79], v1, s[64:67], s15 offen offset:3072 sc1
    s_add_u32 s15, s71, 19931136
    buffer_load_dwordx4 v[80:83], v1, s[64:67], s15 offen offset:0 sc1
    buffer_load_dwordx4 v[84:87], v1, s[64:67], s15 offen offset:1024 sc1
    buffer_load_dwordx4 v[88:91], v1, s[64:67], s15 offen offset:2048 sc1
    buffer_load_dwordx4 v[92:95], v1, s[64:67], s15 offen offset:3072 sc1
    s_add_u32 s15, s71, 19935232
    buffer_load_dwordx4 v[96:99], v1, s[64:67], s15 offen offset:0 sc1
    buffer_load_dwordx4 v[100:103], v1, s[64:67], s15 offen offset:1024 sc1
    buffer_load_dwordx4 v[104:107], v1, s[64:67], s15 offen offset:2048 sc1
    buffer_load_dwordx4 v[108:111], v1, s[64:67], s15 offen offset:3072 sc1
L_29:
    s_waitcnt lgkmcnt(0)
    s_waitcnt vmcnt(12)
    v_mfma_f32_32x32x16_bf16 v[176:191], v[48:51], v[240:243], 0
    v_mfma_f32_32x32x16_bf16 v[176:191], v[52:55], v[244:247], v[176:191]
    v_mfma_f32_32x32x16_bf16 v[176:191], v[56:59], v[248:251], v[176:191]
    v_mfma_f32_32x32x16_bf16 v[176:191], v[60:63], v[252:255], v[176:191]
    s_waitcnt vmcnt(8)
    v_mfma_f32_32x32x16_bf16 v[192:207], v[64:67], v[240:243], 0
    v_mfma_f32_32x32x16_bf16 v[192:207], v[68:71], v[244:247], v[192:207]
    v_mfma_f32_32x32x16_bf16 v[192:207], v[72:75], v[248:251], v[192:207]
    v_mfma_f32_32x32x16_bf16 v[192:207], v[76:79], v[252:255], v[192:207]
    s_nop 6
    v_max_f32 v16, v176, v177
    v_max3_f32 v16, v178, v179, v16
    v_max3_f32 v16, v180, v181, v16
    v_max3_f32 v16, v182, v183, v16
    v_max3_f32 v16, v184, v185, v16
    v_max3_f32 v16, v186, v187, v16
    v_max3_f32 v16, v188, v189, v16
    v_max3_f32 v16, v190, v191, v16
    s_waitcnt vmcnt(4)
    v_mfma_f32_32x32x16_bf16 v[208:223], v[80:83], v[240:243], 0
    v_mfma_f32_32x32x16_bf16 v[208:223], v[84:87], v[244:247], v[208:223]
    v_mfma_f32_32x32x16_bf16 v[208:223], v[88:91], v[248:251], v[208:223]
    v_mfma_f32_32x32x16_bf16 v[208:223], v[92:95], v[252:255], v[208:223]
    v_max3_f32 v16, v192, v193, v16
    v_max3_f32 v16, v194, v195, v16
    v_max3_f32 v16, v196, v197, v16
    v_max3_f32 v16, v198, v199, v16
    v_max3_f32 v16, v200, v201, v16
    v_max3_f32 v16, v202, v203, v16
    v_max3_f32 v16, v204, v205, v16
    v_max3_f32 v16, v206, v207, v16
    s_waitcnt vmcnt(0)
    v_mfma_f32_32x32x16_bf16 v[224:239], v[96:99], v[240:243], 0
    v_mfma_f32_32x32x16_bf16 v[224:239], v[100:103], v[244:247], v[224:239]
    v_mfma_f32_32x32x16_bf16 v[224:239], v[104:107], v[248:251], v[224:239]
    v_mfma_f32_32x32x16_bf16 v[224:239], v[108:111], v[252:255], v[224:239]
    s_add_u32 s15, s71, 20971520
    buffer_load_dwordx4 v[112:115], v1, s[64:67], s15 offen offset:0 sc1
    buffer_load_dwordx4 v[116:119], v1, s[64:67], s15 offen offset:1024 sc1
    buffer_load_dwordx4 v[120:123], v1, s[64:67], s15 offen offset:2048 sc1
    buffer_load_dwordx4 v[124:127], v1, s[64:67], s15 offen offset:3072 sc1
    v_max3_f32 v16, v208, v209, v16
    v_max3_f32 v16, v210, v211, v16
    v_max3_f32 v16, v212, v213, v16
    v_max3_f32 v16, v214, v215, v16
    v_max3_f32 v16, v216, v217, v16
    v_max3_f32 v16, v218, v219, v16
    v_max3_f32 v16, v220, v221, v16
    v_max3_f32 v16, v222, v223, v16
    s_cmp_lg_u32 s77, 7
    s_nop 0
    s_cbranch_scc1 L_30
    v_mov_b32 v228, 0xff800000
    v_mov_b32 v229, 0xff800000
    v_mov_b32 v230, 0xff800000
    v_mov_b32 v231, 0xff800000
    v_mov_b32 v232, 0xff800000
    v_mov_b32 v233, 0xff800000
    v_mov_b32 v234, 0xff800000
    v_mov_b32 v235, 0xff800000
    v_mov_b32 v236, 0xff800000
    v_mov_b32 v237, 0xff800000
    v_mov_b32 v238, 0xff800000
    v_mov_b32 v239, 0xff800000
    s_nop 1
L_30:
    v_max3_f32 v16, v224, v225, v16
    v_max3_f32 v16, v226, v227, v16
    v_max3_f32 v16, v228, v229, v16
    v_max3_f32 v16, v230, v231, v16
    v_max3_f32 v16, v232, v233, v16
    v_max3_f32 v16, v234, v235, v16
    v_max3_f32 v16, v236, v237, v16
    v_max3_f32 v16, v238, v239, v16
    s_add_u32 s15, s71, 20975616
    buffer_load_dwordx4 v[128:131], v1, s[64:67], s15 offen offset:0 sc1
    buffer_load_dwordx4 v[132:135], v1, s[64:67], s15 offen offset:1024 sc1
    buffer_load_dwordx4 v[136:139], v1, s[64:67], s15 offen offset:2048 sc1
    buffer_load_dwordx4 v[140:143], v1, s[64:67], s15 offen offset:3072 sc1
    v_mov_b32 v17, v16
    s_nop 1
    v_permlane32_swap_b32 v16, v17
    v_max_f32 v16, v16, v17
    s_mov_b32 s78, 0x3e38aa3b
    s_mov_b32 s79, 0x3e38aa3b
    v_mul_f32 v20, 0x3e38aa3b, v16
    v_mul_f32 v18, 0xbe38aa3b, v16
    v_pk_fma_f32 v[176:177], v[176:177], s[78:79], v[18:19] op_sel_hi:[1,1,0]
    v_pk_fma_f32 v[178:179], v[178:179], s[78:79], v[18:19] op_sel_hi:[1,1,0]
    v_pk_fma_f32 v[180:181], v[180:181], s[78:79], v[18:19] op_sel_hi:[1,1,0]
    v_pk_fma_f32 v[182:183], v[182:183], s[78:79], v[18:19] op_sel_hi:[1,1,0]
    v_pk_fma_f32 v[184:185], v[184:185], s[78:79], v[18:19] op_sel_hi:[1,1,0]
    v_pk_fma_f32 v[186:187], v[186:187], s[78:79], v[18:19] op_sel_hi:[1,1,0]
    v_pk_fma_f32 v[188:189], v[188:189], s[78:79], v[18:19] op_sel_hi:[1,1,0]
    v_pk_fma_f32 v[190:191], v[190:191], s[78:79], v[18:19] op_sel_hi:[1,1,0]
    v_exp_f32 v176, v176
    v_exp_f32 v177, v177
    v_exp_f32 v178, v178
    v_exp_f32 v179, v179
    v_exp_f32 v180, v180
    v_exp_f32 v181, v181
    v_exp_f32 v182, v182
    v_exp_f32 v183, v183
    v_exp_f32 v184, v184
    v_exp_f32 v185, v185
    v_exp_f32 v186, v186
    v_exp_f32 v187, v187
    v_exp_f32 v188, v188
    v_exp_f32 v189, v189
    v_exp_f32 v190, v190
    v_exp_f32 v191, v191
    v_pk_add_f32 v[22:23], v[176:177], v[178:179]
    v_pk_add_f32 v[22:23], v[22:23], v[180:181]
    v_pk_add_f32 v[22:23], v[22:23], v[182:183]
    v_pk_add_f32 v[22:23], v[22:23], v[184:185]
    v_pk_add_f32 v[22:23], v[22:23], v[186:187]
    v_pk_add_f32 v[22:23], v[22:23], v[188:189]
    v_pk_add_f32 v[22:23], v[22:23], v[190:191]
    v_cvt_pk_bf16_f32 v176, v176, v177
    v_cvt_pk_bf16_f32 v177, v178, v179
    v_cvt_pk_bf16_f32 v178, v180, v181
    v_cvt_pk_bf16_f32 v179, v182, v183
    v_cvt_pk_bf16_f32 v180, v184, v185
    v_cvt_pk_bf16_f32 v181, v186, v187
    v_cvt_pk_bf16_f32 v182, v188, v189
    v_cvt_pk_bf16_f32 v183, v190, v191
    s_add_u32 s15, s71, 20979712
    buffer_load_dwordx4 v[144:147], v1, s[64:67], s15 offen offset:0 sc1
    buffer_load_dwordx4 v[148:151], v1, s[64:67], s15 offen offset:1024 sc1
    buffer_load_dwordx4 v[152:155], v1, s[64:67], s15 offen offset:2048 sc1
    buffer_load_dwordx4 v[156:159], v1, s[64:67], s15 offen offset:3072 sc1
    v_pk_fma_f32 v[192:193], v[192:193], s[78:79], v[18:19] op_sel_hi:[1,1,0]
    v_pk_fma_f32 v[194:195], v[194:195], s[78:79], v[18:19] op_sel_hi:[1,1,0]
    v_pk_fma_f32 v[196:197], v[196:197], s[78:79], v[18:19] op_sel_hi:[1,1,0]
    v_pk_fma_f32 v[198:199], v[198:199], s[78:79], v[18:19] op_sel_hi:[1,1,0]
    v_pk_fma_f32 v[200:201], v[200:201], s[78:79], v[18:19] op_sel_hi:[1,1,0]
    v_pk_fma_f32 v[202:203], v[202:203], s[78:79], v[18:19] op_sel_hi:[1,1,0]
    v_pk_fma_f32 v[204:205], v[204:205], s[78:79], v[18:19] op_sel_hi:[1,1,0]
    v_pk_fma_f32 v[206:207], v[206:207], s[78:79], v[18:19] op_sel_hi:[1,1,0]
    v_exp_f32 v192, v192
    v_exp_f32 v193, v193
    v_exp_f32 v194, v194
    v_exp_f32 v195, v195
    v_exp_f32 v196, v196
    v_exp_f32 v197, v197
    v_exp_f32 v198, v198
    v_exp_f32 v199, v199
    v_exp_f32 v200, v200
    v_exp_f32 v201, v201
    v_exp_f32 v202, v202
    v_exp_f32 v203, v203
    v_exp_f32 v204, v204
    v_exp_f32 v205, v205
    v_exp_f32 v206, v206
    v_exp_f32 v207, v207
    v_pk_add_f32 v[22:23], v[22:23], v[192:193]
    v_pk_add_f32 v[22:23], v[22:23], v[194:195]
    v_pk_add_f32 v[22:23], v[22:23], v[196:197]
    v_pk_add_f32 v[22:23], v[22:23], v[198:199]
    v_pk_add_f32 v[22:23], v[22:23], v[200:201]
    v_pk_add_f32 v[22:23], v[22:23], v[202:203]
    v_pk_add_f32 v[22:23], v[22:23], v[204:205]
    v_pk_add_f32 v[22:23], v[22:23], v[206:207]
    v_cvt_pk_bf16_f32 v192, v192, v193
    v_cvt_pk_bf16_f32 v193, v194, v195
    v_cvt_pk_bf16_f32 v194, v196, v197
    v_cvt_pk_bf16_f32 v195, v198, v199
    v_cvt_pk_bf16_f32 v196, v200, v201
    v_cvt_pk_bf16_f32 v197, v202, v203
    v_cvt_pk_bf16_f32 v198, v204, v205
    v_cvt_pk_bf16_f32 v199, v206, v207
    s_add_u32 s15, s71, 20983808
    buffer_load_dwordx4 v[160:163], v1, s[64:67], s15 offen offset:0 sc1
    buffer_load_dwordx4 v[164:167], v1, s[64:67], s15 offen offset:1024 sc1
    buffer_load_dwordx4 v[168:171], v1, s[64:67], s15 offen offset:2048 sc1
    buffer_load_dwordx4 v[172:175], v1, s[64:67], s15 offen offset:3072 sc1
    s_waitcnt vmcnt(12)
    v_mfma_f32_32x32x16_bf16 v[48:63], v[112:115], v[176:179], 0
    v_mfma_f32_32x32x16_bf16 v[64:79], v[120:123], v[176:179], 0
    v_mfma_f32_32x32x16_bf16 v[48:63], v[116:119], v[180:183], v[48:63]
    v_mfma_f32_32x32x16_bf16 v[64:79], v[124:127], v[180:183], v[64:79]
    v_pk_fma_f32 v[208:209], v[208:209], s[78:79], v[18:19] op_sel_hi:[1,1,0]
    v_pk_fma_f32 v[210:211], v[210:211], s[78:79], v[18:19] op_sel_hi:[1,1,0]
    v_pk_fma_f32 v[212:213], v[212:213], s[78:79], v[18:19] op_sel_hi:[1,1,0]
    v_pk_fma_f32 v[214:215], v[214:215], s[78:79], v[18:19] op_sel_hi:[1,1,0]
    v_pk_fma_f32 v[216:217], v[216:217], s[78:79], v[18:19] op_sel_hi:[1,1,0]
    v_pk_fma_f32 v[218:219], v[218:219], s[78:79], v[18:19] op_sel_hi:[1,1,0]
    v_pk_fma_f32 v[220:221], v[220:221], s[78:79], v[18:19] op_sel_hi:[1,1,0]
    v_pk_fma_f32 v[222:223], v[222:223], s[78:79], v[18:19] op_sel_hi:[1,1,0]
    v_exp_f32 v208, v208
    v_exp_f32 v209, v209
    v_exp_f32 v210, v210
    v_exp_f32 v211, v211
    v_exp_f32 v212, v212
    v_exp_f32 v213, v213
    v_exp_f32 v214, v214
    v_exp_f32 v215, v215
    v_exp_f32 v216, v216
    v_exp_f32 v217, v217
    v_exp_f32 v218, v218
    v_exp_f32 v219, v219
    v_exp_f32 v220, v220
    v_exp_f32 v221, v221
    v_exp_f32 v222, v222
    v_exp_f32 v223, v223
    v_pk_add_f32 v[22:23], v[22:23], v[208:209]
    v_pk_add_f32 v[22:23], v[22:23], v[210:211]
    v_pk_add_f32 v[22:23], v[22:23], v[212:213]
    v_pk_add_f32 v[22:23], v[22:23], v[214:215]
    v_pk_add_f32 v[22:23], v[22:23], v[216:217]
    v_pk_add_f32 v[22:23], v[22:23], v[218:219]
    v_pk_add_f32 v[22:23], v[22:23], v[220:221]
    v_pk_add_f32 v[22:23], v[22:23], v[222:223]
    v_cvt_pk_bf16_f32 v208, v208, v209
    v_cvt_pk_bf16_f32 v209, v210, v211
    v_cvt_pk_bf16_f32 v210, v212, v213
    v_cvt_pk_bf16_f32 v211, v214, v215
    v_cvt_pk_bf16_f32 v212, v216, v217
    v_cvt_pk_bf16_f32 v213, v218, v219
    v_cvt_pk_bf16_f32 v214, v220, v221
    v_cvt_pk_bf16_f32 v215, v222, v223
    v_mul_u32_u24 v32, 1024, v3
    v_add_u32 v32, v32, v4
    v_xor_b32 v33, 32, v32
    s_lshl_b32 s75, s11, 3
    s_lshl_b32 s14, s5, 7
    s_add_u32 s75, s75, s14
    s_add_u32 m0, s11, 65536
    s_add_u32 s15, s75, 0
    buffer_load_dwordx4 v32, s[36:39], s15 offen lds
    s_add_u32 m0, s11, 97792
    s_nop 0
    buffer_load_dwordx4 v33, s[36:39], s15 offen offset:512 lds
    s_add_u32 m0, s11, 73728
    s_add_u32 s15, s75, 65536
    buffer_load_dwordx4 v32, s[36:39], s15 offen lds
    s_add_u32 m0, s11, 105984
    s_nop 0
    buffer_load_dwordx4 v33, s[36:39], s15 offen offset:512 lds
    s_add_u32 m0, s11, 81920
    s_add_u32 s15, s75, 131072
    buffer_load_dwordx4 v32, s[36:39], s15 offen lds
    s_add_u32 m0, s11, 114176
    s_nop 0
    buffer_load_dwordx4 v33, s[36:39], s15 offen offset:512 lds
    s_add_u32 m0, s11, 90112
    s_add_u32 s15, s75, 196608
    buffer_load_dwordx4 v32, s[36:39], s15 offen lds
    s_add_u32 m0, s11, 122368
    s_nop 0
    buffer_load_dwordx4 v33, s[36:39], s15 offen offset:512 lds
    s_waitcnt vmcnt(16)
    v_mfma_f32_32x32x16_bf16 v[48:63], v[128:131], v[192:195], v[48:63]
    v_mfma_f32_32x32x16_bf16 v[64:79], v[136:139], v[192:195], v[64:79]
    v_mfma_f32_32x32x16_bf16 v[48:63], v[132:135], v[196:199], v[48:63]
    v_mfma_f32_32x32x16_bf16 v[64:79], v[140:143], v[196:199], v[64:79]
    v_pk_fma_f32 v[224:225], v[224:225], s[78:79], v[18:19] op_sel_hi:[1,1,0]
    v_pk_fma_f32 v[226:227], v[226:227], s[78:79], v[18:19] op_sel_hi:[1,1,0]
    v_pk_fma_f32 v[228:229], v[228:229], s[78:79], v[18:19] op_sel_hi:[1,1,0]
    v_pk_fma_f32 v[230:231], v[230:231], s[78:79], v[18:19] op_sel_hi:[1,1,0]
    v_pk_fma_f32 v[232:233], v[232:233], s[78:79], v[18:19] op_sel_hi:[1,1,0]
    v_pk_fma_f32 v[234:235], v[234:235], s[78:79], v[18:19] op_sel_hi:[1,1,0]
    v_pk_fma_f32 v[236:237], v[236:237], s[78:79], v[18:19] op_sel_hi:[1,1,0]
    v_pk_fma_f32 v[238:239], v[238:239], s[78:79], v[18:19] op_sel_hi:[1,1,0]
    v_exp_f32 v224, v224
    v_exp_f32 v225, v225
    v_exp_f32 v226, v226
    v_exp_f32 v227, v227
    v_exp_f32 v228, v228
    v_exp_f32 v229, v229
    v_exp_f32 v230, v230
    v_exp_f32 v231, v231
    v_exp_f32 v232, v232
    v_exp_f32 v233, v233
    v_exp_f32 v234, v234
    v_exp_f32 v235, v235
    v_exp_f32 v236, v236
    v_exp_f32 v237, v237
    v_exp_f32 v238, v238
    v_exp_f32 v239, v239
    v_pk_add_f32 v[22:23], v[22:23], v[224:225]
    v_pk_add_f32 v[22:23], v[22:23], v[226:227]
    v_pk_add_f32 v[22:23], v[22:23], v[228:229]
    v_pk_add_f32 v[22:23], v[22:23], v[230:231]
    v_pk_add_f32 v[22:23], v[22:23], v[232:233]
    v_pk_add_f32 v[22:23], v[22:23], v[234:235]
    v_pk_add_f32 v[22:23], v[22:23], v[236:237]
    v_pk_add_f32 v[22:23], v[22:23], v[238:239]
    v_cvt_pk_bf16_f32 v224, v224, v225
    v_cvt_pk_bf16_f32 v225, v226, v227
    v_cvt_pk_bf16_f32 v226, v228, v229
    v_cvt_pk_bf16_f32 v227, v230, v231
    v_cvt_pk_bf16_f32 v228, v232, v233
    v_cvt_pk_bf16_f32 v229, v234, v235
    v_cvt_pk_bf16_f32 v230, v236, v237
    v_cvt_pk_bf16_f32 v231, v238, v239
    s_waitcnt vmcnt(12)
    v_mfma_f32_32x32x16_bf16 v[48:63], v[144:147], v[208:211], v[48:63]
    v_mfma_f32_32x32x16_bf16 v[64:79], v[152:155], v[208:211], v[64:79]
    v_mfma_f32_32x32x16_bf16 v[48:63], v[148:151], v[212:215], v[48:63]
    v_mfma_f32_32x32x16_bf16 v[64:79], v[156:159], v[212:215], v[64:79]
    s_waitcnt vmcnt(8)
    v_mfma_f32_32x32x16_bf16 v[48:63], v[160:163], v[224:227], v[48:63]
    v_mfma_f32_32x32x16_bf16 v[64:79], v[168:171], v[224:227], v[64:79]
    v_mfma_f32_32x32x16_bf16 v[48:63], v[164:167], v[228:231], v[48:63]
    v_mfma_f32_32x32x16_bf16 v[64:79], v[172:175], v[228:231], v[64:79]
    s_lshl_b32 s77, s6, 5
    s_add_u32 s77, s77, s9
    s_lshl_b32 s14, s77, 14
    s_add_u32 s14, s14, s69
    s_add_u32 s14, s14, 17825792
    s_cmp_lg_u32 s8, 0
    s_nop 5
    s_cbranch_scc1 L_31
    buffer_load_dwordx4 v[40:43], v1, s[64:67], s14 offen sc1
    buffer_load_dwordx4 v[44:47], v1, s[64:67], s14 offen offset:1024 sc1
L_31:
    v_add_f32 v21, v22, v23
    v_mov_b32 v22, v21
    s_nop 1
    v_permlane32_swap_b32 v21, v22
    v_add_f32 v21, v21, v22
    s_lshl_b32 s14, s3, 8
    v_lshlrev_b32 v24, 3, v5
    v_add_u32 v25, s14, v24
    ds_write_b64 v25, v[20:21] offset:32768
    s_lshl_b32 s14, s3, 12
    v_add_u32 v25, s14, v1
    v_cvt_pk_bf16_f32 v112, v48, v49
    v_cvt_pk_bf16_f32 v113, v50, v51
    v_cvt_pk_bf16_f32 v114, v52, v53
    v_cvt_pk_bf16_f32 v115, v54, v55
    v_cvt_pk_bf16_f32 v116, v56, v57
    v_cvt_pk_bf16_f32 v117, v58, v59
    v_cvt_pk_bf16_f32 v118, v60, v61
    v_cvt_pk_bf16_f32 v119, v62, v63
    v_cvt_pk_bf16_f32 v120, v64, v65
    v_cvt_pk_bf16_f32 v121, v66, v67
    v_cvt_pk_bf16_f32 v122, v68, v69
    v_cvt_pk_bf16_f32 v123, v70, v71
    v_cvt_pk_bf16_f32 v124, v72, v73
    v_cvt_pk_bf16_f32 v125, v74, v75
    v_cvt_pk_bf16_f32 v126, v76, v77
    v_cvt_pk_bf16_f32 v127, v78, v79
    ds_write_b128 v25, v[112:115] offset:0
    ds_write_b128 v25, v[116:119] offset:1024
    ds_write_b128 v25, v[120:123] offset:2048
    ds_write_b128 v25, v[124:127] offset:3072
    s_lshr_b32 s14, s3, 1
    s_lshl_b32 s14, s14, 10
    s_and_b32 s15, s3, 1
    s_lshl_b32 s15, s15, 3
    s_add_u32 s14, s14, s15
    v_add_u32 v25, s14, v1
    v_add_u32 v24, 32768, v24
    s_waitcnt lgkmcnt(0)
    s_barrier
    ds_read2_b64 v[112:115], v24 offset0:0 offset1:32
    ds_read2_b64 v[116:119], v24 offset0:64 offset1:96
    ds_read2_b64 v[120:123], v24 offset0:128 offset1:160
    ds_read2_b64 v[124:127], v24 offset0:192 offset1:224
    ds_read2st64_b64 v[128:131], v25 offset0:0 offset1:8
    ds_read2st64_b64 v[132:135], v25 offset0:16 offset1:24
    ds_read2st64_b64 v[136:139], v25 offset0:32 offset1:40
    ds_read2st64_b64 v[140:143], v25 offset0:48 offset1:56
    v_lshlrev_b32 v33, 7, v0
    s_mul_i32 s15, s98, 2048
    s_mov_b64 exec, 65535
    buffer_load_dword v80, v33, s[48:51], s15 offen sc1
    s_mov_b64 exec, -1
    s_waitcnt lgkmcnt(4)
    v_max3_f32 v16, v112, v114, v116
    v_max3_f32 v16, v118, v120, v16
    v_max3_f32 v16, v122, v124, v16
    v_max_f32 v16, v126, v16
    v_sub_f32 v112, v112, v16
    v_sub_f32 v114, v114, v16
    v_sub_f32 v116, v116, v16
    v_sub_f32 v118, v118, v16
    v_sub_f32 v120, v120, v16
    v_sub_f32 v122, v122, v16
    v_sub_f32 v124, v124, v16
    v_sub_f32 v126, v126, v16
    v_exp_f32 v112, v112
    v_exp_f32 v114, v114
    v_exp_f32 v116, v116
    v_exp_f32 v118, v118
    v_exp_f32 v120, v120
    v_exp_f32 v122, v122
    v_exp_f32 v124, v124
    v_exp_f32 v126, v126
    v_mul_f32 v17, v112, v113
    v_fmac_f32 v17, v114, v115
    v_fmac_f32 v17, v116, v117
    v_fmac_f32 v17, v118, v119
    v_fmac_f32 v17, v120, v121
    v_fmac_f32 v17, v122, v123
    v_fmac_f32 v17, v124, v125
    v_fmac_f32 v17, v126, v127
    v_rcp_f32 v18, v17
    s_waitcnt lgkmcnt(0)
    v_lshlrev_b32 v144, 16, v128
    v_and_b32 v145, 0xffff0000, v128
    v_lshlrev_b32 v146, 16, v129
    v_and_b32 v147, 0xffff0000, v129
    v_pk_mul_f32 v[20:21], v[144:145], v[112:113] op_sel_hi:[1,0]
    v_pk_mul_f32 v[22:23], v[146:147], v[112:113] op_sel_hi:[1,0]
    v_lshlrev_b32 v148, 16, v130
    v_and_b32 v149, 0xffff0000, v130
    v_lshlrev_b32 v150, 16, v131
    v_and_b32 v151, 0xffff0000, v131
    v_pk_fma_f32 v[20:21], v[148:149], v[114:115], v[20:21] op_sel_hi:[1,0,1]
    v_pk_fma_f32 v[22:23], v[150:151], v[114:115], v[22:23] op_sel_hi:[1,0,1]
    v_lshlrev_b32 v144, 16, v132
    v_and_b32 v145, 0xffff0000, v132
    v_lshlrev_b32 v146, 16, v133
    v_and_b32 v147, 0xffff0000, v133
    v_pk_fma_f32 v[20:21], v[144:145], v[116:117], v[20:21] op_sel_hi:[1,0,1]
    v_pk_fma_f32 v[22:23], v[146:147], v[116:117], v[22:23] op_sel_hi:[1,0,1]
    v_lshlrev_b32 v148, 16, v134
    v_and_b32 v149, 0xffff0000, v134
    v_lshlrev_b32 v150, 16, v135
    v_and_b32 v151, 0xffff0000, v135
    v_pk_fma_f32 v[20:21], v[148:149], v[118:119], v[20:21] op_sel_hi:[1,0,1]
    v_pk_fma_f32 v[22:23], v[150:151], v[118:119], v[22:23] op_sel_hi:[1,0,1]
    v_lshlrev_b32 v144, 16, v136
    v_and_b32 v145, 0xffff0000, v136
    v_lshlrev_b32 v146, 16, v137
    v_and_b32 v147, 0xffff0000, v137
    v_pk_fma_f32 v[20:21], v[144:145], v[120:121], v[20:21] op_sel_hi:[1,0,1]
    v_pk_fma_f32 v[22:23], v[146:147], v[120:121], v[22:23] op_sel_hi:[1,0,1]
    v_lshlrev_b32 v148, 16, v138
    v_and_b32 v149, 0xffff0000, v138
    v_lshlrev_b32 v150, 16, v139
    v_and_b32 v151, 0xffff0000, v139
    v_pk_fma_f32 v[20:21], v[148:149], v[122:123], v[20:21] op_sel_hi:[1,0,1]
    v_pk_fma_f32 v[22:23], v[150:151], v[122:123], v[22:23] op_sel_hi:[1,0,1]
    v_lshlrev_b32 v144, 16, v140
    v_and_b32 v145, 0xffff0000, v140
    v_lshlrev_b32 v146, 16, v141
    v_and_b32 v147, 0xffff0000, v141
    v_pk_fma_f32 v[20:21], v[144:145], v[124:125], v[20:21] op_sel_hi:[1,0,1]
    v_pk_fma_f32 v[22:23], v[146:147], v[124:125], v[22:23] op_sel_hi:[1,0,1]
    v_lshlrev_b32 v148, 16, v142
    v_and_b32 v149, 0xffff0000, v142
    v_lshlrev_b32 v150, 16, v143
    v_and_b32 v151, 0xffff0000, v143
    v_pk_fma_f32 v[20:21], v[148:149], v[126:127], v[20:21] op_sel_hi:[1,0,1]
    v_pk_fma_f32 v[22:23], v[150:151], v[126:127], v[22:23] op_sel_hi:[1,0,1]
    v_pk_mul_f32 v[20:21], v[20:21], v[18:19] op_sel_hi:[1,0]
    v_pk_mul_f32 v[22:23], v[22:23], v[18:19] op_sel_hi:[1,0]
    v_cvt_pk_bf16_f32 v26, v20, v21
    v_cvt_pk_bf16_f32 v27, v22, v23
    ds_write_b64 v25, v[26:27] offset:36864
    s_waitcnt vmcnt(1) lgkmcnt(0)
    s_barrier
    ds_read_b64_tr_b16 v[112:113], v38 offset:32768
    ds_read_b64_tr_b16 v[114:115], v38 offset:33280
    ds_read_b128 v[116:119], v1 offset:36864
    ds_read_b64_tr_b16 v[120:121], v38 offset:34816
    ds_read_b64_tr_b16 v[122:123], v38 offset:35328
    ds_read_b128 v[124:127], v1 offset:37888
    ds_read_b64_tr_b16 v[128:129], v38 offset:36864
    ds_read_b64_tr_b16 v[130:131], v38 offset:37376
    ds_read_b128 v[132:135], v1 offset:38912
    ds_read_b64_tr_b16 v[136:137], v38 offset:38912
    ds_read_b64_tr_b16 v[138:139], v38 offset:39424
    ds_read_b128 v[140:143], v1 offset:39936
    s_waitcnt lgkmcnt(6)
    v_mfma_f32_32x32x16_bf16 v[16:31], v[112:115], v[116:119], 0
    v_mfma_f32_32x32x16_bf16 v[16:31], v[120:123], v[124:127], v[16:31]
    s_waitcnt lgkmcnt(0)
    v_mfma_f32_32x32x16_bf16 v[16:31], v[128:131], v[132:135], v[16:31]
    v_mfma_f32_32x32x16_bf16 v[16:31], v[136:139], v[140:143], v[16:31]
    s_cmp_lg_u32 s8, 0
    s_nop 10
    s_cbranch_scc1 L_32
    s_waitcnt vmcnt(1)
    v_mfma_f32_32x32x16_bf16 v[16:31], v[8:11], v[40:43], v[16:31]
    v_mfma_f32_32x32x16_bf16 v[16:31], v[12:15], v[44:47], v[16:31]
    s_nop 11
L_32:
    v_cvt_pk_bf16_f32 v48, v16, v17
    v_cvt_pk_bf16_f32 v49, v18, v19
    v_cvt_pk_bf16_f32 v50, v20, v21
    v_cvt_pk_bf16_f32 v51, v22, v23
    v_cvt_pk_bf16_f32 v52, v24, v25
    v_cvt_pk_bf16_f32 v53, v26, v27
    v_cvt_pk_bf16_f32 v54, v28, v29
    v_cvt_pk_bf16_f32 v55, v30, v31
    s_lshl_b32 s14, s77, 16
    s_lshl_b32 s15, s8, 14
    s_add_u32 s14, s14, s15
    s_add_u32 s14, s14, s69
    s_add_u32 s14, s14, 5242880
    buffer_store_dwordx4 v[48:51], v1, s[64:67], s14 offen sc1
    buffer_store_dwordx4 v[52:55], v1, s[64:67], s14 offen offset:1024 sc1
    s_lshl_b32 s75, s77, 10
    s_lshl_b32 s14, s8, 7
    s_add_u32 s75, s75, s14
    s_add_u32 s75, s75, 23134208
    s_add_u32 s76, s74, 23133184
    s_cmp_eq_u32 s7, 0
    s_cselect_b32 s78, 1, 0
    s_cmp_eq_u32 s7, 31
    s_cselect_b32 s79, 1, 2
    v_bfe_u32 v56, v0, 2, 2
    v_mov_b32 v57, 1
    v_mov_b32 v58, s78
    v_mov_b32 v59, s79
    v_cmp_eq_u32 vcc, 0, v56
    s_nop 1
    v_cndmask_b32 v57, v57, v58, vcc
    v_cmp_eq_u32 vcc, 2, v56
    s_nop 1
    v_cndmask_b32 v57, v57, v59, vcc
    v_and_b32 v56, 3, v0
    v_lshlrev_b32 v56, 7, v56
    v_lshl_add_u32 v56, v57, 10, v56
    v_cmp_gt_u32 vcc, 16, v5
    s_nop 1
    v_cndmask_b32 v57, v59, v58, vcc
    v_xor_b32 v58, 256, v1
    v_lshl_add_u32 v57, v57, 16, v58
    s_and_b32 s14, s3, 3
    s_and_b32 s15, s14, 1
    s_lshl_b32 s15, s15, 5
    v_xor_b32 v59, s15, v2
    v_bfe_u32 v61, v0, 4, 1
    v_lshl_add_u32 v59, v61, 15, v59
    s_lshr_b32 s14, s14, 1
    s_lshl_b32 s14, s14, 8
    s_add_u32 s14, s14, 65536
    v_add_u32 v59, s14, v59
    ds_read_b64_tr_b16 v[128:129], v59 offset:0
    ds_read_b64_tr_b16 v[130:131], v59 offset:512
    ds_read_b64_tr_b16 v[132:133], v59 offset:2048
    ds_read_b64_tr_b16 v[134:135], v59 offset:2560
    ds_read_b64_tr_b16 v[136:137], v59 offset:4096
    ds_read_b64_tr_b16 v[138:139], v59 offset:4608
    ds_read_b64_tr_b16 v[140:141], v59 offset:6144
    ds_read_b64_tr_b16 v[142:143], v59 offset:6656
    s_waitcnt lgkmcnt(6)
    ds_read_b64_tr_b16 v[144:145], v59 offset:8192
    ds_read_b64_tr_b16 v[146:147], v59 offset:8704
    ds_read_b64_tr_b16 v[148:149], v59 offset:10240
    ds_read_b64_tr_b16 v[150:151], v59 offset:10752
    ds_read_b64_tr_b16 v[152:153], v59 offset:12288
    ds_read_b64_tr_b16 v[154:155], v59 offset:12800
    ds_read_b64_tr_b16 v[156:157], v59 offset:14336
    ds_read_b64_tr_b16 v[158:159], v59 offset:14848
    s_waitcnt lgkmcnt(6)
    ds_read_b64_tr_b16 v[160:161], v59 offset:16384
    ds_read_b64_tr_b16 v[162:163], v59 offset:16896
    ds_read_b64_tr_b16 v[164:165], v59 offset:18432
    ds_read_b64_tr_b16 v[166:167], v59 offset:18944
    ds_read_b64_tr_b16 v[168:169], v59 offset:20480
    ds_read_b64_tr_b16 v[170:171], v59 offset:20992
    ds_read_b64_tr_b16 v[172:173], v59 offset:22528
    ds_read_b64_tr_b16 v[174:175], v59 offset:23040
    s_waitcnt lgkmcnt(6)
    ds_read_b64_tr_b16 v[176:177], v59 offset:24576
    ds_read_b64_tr_b16 v[178:179], v59 offset:25088
    ds_read_b64_tr_b16 v[180:181], v59 offset:26624
    ds_read_b64_tr_b16 v[182:183], v59 offset:27136
    ds_read_b64_tr_b16 v[184:185], v59 offset:28672
    ds_read_b64_tr_b16 v[186:187], v59 offset:29184
    ds_read_b64_tr_b16 v[188:189], v59 offset:30720
    ds_read_b64_tr_b16 v[190:191], v59 offset:31232
    s_waitcnt vmcnt(0) lgkmcnt(0)
    s_barrier
    s_cmp_lg_u32 s3, 0
    s_cbranch_scc1 L_34
    v_mov_b32 v36, 0
    v_mov_b32 v34, s12
    v_mov_b32 v35, s13
    s_mov_b64 exec, 1
    buffer_store_dwordx2 v[34:35], v36, s[64:67], s75 offen sc1
    s_mov_b64 exec, -1
L_34:
    s_cmp_lt_u32 s3, 4
    s_cbranch_scc1 L_33
    v_mul_u32_u24 v32, 512, v3
    v_add_u32 v32, v32, v4
    s_lshl_b32 s71, s68, 2
    s_lshl_b32 s14, s5, 15
    s_add_u32 s71, s71, s14
    s_add_u32 m0, s68, 131072
    s_add_u32 s15, s71, 0
    buffer_load_dwordx4 v32, s[44:47], s15 offen lds
    v_mov_b32 v248, 0x3f803f80
    v_mov_b32 v249, 0x3f803f80
    v_mov_b32 v250, 0x3f803f80
    v_mov_b32 v251, 0x3f803f80
    v_lshlrev_b32 v62, 1, v0
    s_add_u32 m0, s68, 139136
    s_nop 0
    buffer_load_dwordx4 v32, s[44:47], s15 offen offset:128 lds
    v_mov_b32 v192, 0
    v_mov_b32 v193, 0
    v_mfma_f32_32x32x16_bf16 v[224:239], v[128:131], v[248:251], 0
    ds_read_u16_d16_hi v192, v62 offset:61440
    ds_read_u16_d16_hi v193, v62 offset:61568
    s_add_u32 m0, s68, 147200
    s_nop 0
    buffer_load_dwordx4 v32, s[44:47], s15 offen offset:256 lds
    v_mov_b32 v194, 0
    v_mov_b32 v195, 0
    v_mfma_f32_32x32x16_bf16 v[224:239], v[132:135], v[248:251], v[224:239]
    ds_read_u16_d16_hi v194, v62 offset:61696
    ds_read_u16_d16_hi v195, v62 offset:61824
    s_add_u32 m0, s68, 155264
    s_nop 0
    buffer_load_dwordx4 v32, s[44:47], s15 offen offset:384 lds
    v_mov_b32 v196, 0
    v_mov_b32 v197, 0
    v_mfma_f32_32x32x16_bf16 v[224:239], v[136:139], v[248:251], v[224:239]
    ds_read_u16_d16_hi v196, v62 offset:61952
    ds_read_u16_d16_hi v197, v62 offset:62080
    s_add_u32 m0, s68, 135168
    s_add_u32 s15, s71, 16384
    buffer_load_dwordx4 v32, s[44:47], s15 offen lds
    v_mov_b32 v198, 0
    v_mov_b32 v199, 0
    v_mfma_f32_32x32x16_bf16 v[224:239], v[140:143], v[248:251], v[224:239]
    ds_read_u16_d16_hi v198, v62 offset:62208
    ds_read_u16_d16_hi v199, v62 offset:62336
    s_add_u32 m0, s68, 143232
    s_nop 0
    buffer_load_dwordx4 v32, s[44:47], s15 offen offset:128 lds
    v_mov_b32 v200, 0
    v_mov_b32 v201, 0
    v_mfma_f32_32x32x16_bf16 v[224:239], v[144:147], v[248:251], v[224:239]
    s_waitcnt lgkmcnt(6)
    ds_read_u16_d16_hi v200, v62 offset:62464
    s_add_u32 m0, s68, 151296
    s_nop 0
    buffer_load_dwordx4 v32, s[44:47], s15 offen offset:256 lds
    ds_read_u16_d16_hi v201, v62 offset:62592
    v_mov_b32 v202, 0
    v_mov_b32 v203, 0
    v_mfma_f32_32x32x16_bf16 v[224:239], v[148:151], v[248:251], v[224:239]
    ds_read_u16_d16_hi v202, v62 offset:62720
    s_add_u32 m0, s68, 159360
    s_nop 0
    buffer_load_dwordx4 v32, s[44:47], s15 offen offset:384 lds
    ds_read_u16_d16_hi v203, v62 offset:62848
    v_mov_b32 v204, 0
    v_mov_b32 v205, 0
    v_mfma_f32_32x32x16_bf16 v[224:239], v[152:155], v[248:251], v[224:239]
    ds_read_u16_d16_hi v204, v62 offset:62976
    v_mul_u32_u24 v32, 2048, v3
    v_add_u32 v32, v32, v4
    s_lshl_b32 s71, s68, 4
    s_lshl_b32 s14, s5, 9
    s_add_u32 s71, s71, s14
    s_add_u32 m0, s68, 65536
    s_add_u32 s15, s71, 0
    buffer_load_dwordx4 v32, s[48:51], s15 offen lds
    ds_read_u16_d16_hi v205, v62 offset:63104
    v_mov_b32 v206, 0
    v_mov_b32 v207, 0
    v_mfma_f32_32x32x16_bf16 v[224:239], v[156:159], v[248:251], v[224:239]
    ds_read_u16_d16_hi v206, v62 offset:63232
    s_add_u32 m0, s68, 73600
    s_nop 0
    buffer_load_dwordx4 v32, s[48:51], s15 offen offset:128 lds
    ds_read_u16_d16_hi v207, v62 offset:63360
    v_mov_b32 v208, 0
    v_mov_b32 v209, 0
    v_mfma_f32_32x32x16_bf16 v[224:239], v[160:163], v[248:251], v[224:239]
    s_waitcnt lgkmcnt(6)
    s_add_u32 m0, s68, 81664
    s_nop 0
    buffer_load_dwordx4 v32, s[48:51], s15 offen offset:256 lds
    ds_read_u16_d16_hi v208, v62 offset:63488
    ds_read_u16_d16_hi v209, v62 offset:63616
    v_mov_b32 v210, 0
    v_mov_b32 v211, 0
    v_mfma_f32_32x32x16_bf16 v[224:239], v[164:167], v[248:251], v[224:239]
    s_add_u32 m0, s68, 89728
    s_nop 0
    buffer_load_dwordx4 v32, s[48:51], s15 offen offset:384 lds
    ds_read_u16_d16_hi v210, v62 offset:63744
    ds_read_u16_d16_hi v211, v62 offset:63872
    v_mov_b32 v212, 0
    v_mov_b32 v213, 0
    v_mfma_f32_32x32x16_bf16 v[224:239], v[168:171], v[248:251], v[224:239]
    s_add_u32 m0, s68, 69632
    s_add_u32 s15, s71, 65536
    buffer_load_dwordx4 v32, s[48:51], s15 offen lds
    ds_read_u16_d16_hi v212, v62 offset:64000
    ds_read_u16_d16_hi v213, v62 offset:64128
    v_mov_b32 v214, 0
    v_mov_b32 v215, 0
    v_mfma_f32_32x32x16_bf16 v[224:239], v[172:175], v[248:251], v[224:239]
    s_add_u32 m0, s68, 77696
    s_nop 0
    buffer_load_dwordx4 v32, s[48:51], s15 offen offset:128 lds
    ds_read_u16_d16_hi v214, v62 offset:64256
    ds_read_u16_d16_hi v215, v62 offset:64384
    v_mov_b32 v216, 0
    v_mov_b32 v217, 0
    v_mfma_f32_32x32x16_bf16 v[224:239], v[176:179], v[248:251], v[224:239]
    s_add_u32 m0, s68, 85760
    s_nop 0
    buffer_load_dwordx4 v32, s[48:51], s15 offen offset:256 lds
    s_waitcnt lgkmcnt(6)
    ds_read_u16_d16_hi v216, v62 offset:64512
    ds_read_u16_d16_hi v217, v62 offset:64640
    v_mov_b32 v218, 0
    v_mov_b32 v219, 0
    s_add_u32 m0, s68, 93824
    s_nop 0
    buffer_load_dwordx4 v32, s[48:51], s15 offen offset:384 lds
    v_mfma_f32_32x32x16_bf16 v[224:239], v[180:183], v[248:251], v[224:239]
    ds_read_u16_d16_hi v218, v62 offset:64768
    ds_read_u16_d16_hi v219, v62 offset:64896
    v_mov_b32 v220, 0
    v_mov_b32 v221, 0
    s_add_u32 m0, s68, 98304
    s_add_u32 s15, s71, 131072
    buffer_load_dwordx4 v32, s[48:51], s15 offen lds
    v_mfma_f32_32x32x16_bf16 v[224:239], v[184:187], v[248:251], v[224:239]
    ds_read_u16_d16_hi v220, v62 offset:65024
    ds_read_u16_d16_hi v221, v62 offset:65152
    v_mov_b32 v222, 0
    v_mov_b32 v223, 0
    s_add_u32 m0, s68, 106368
    s_nop 0
    buffer_load_dwordx4 v32, s[48:51], s15 offen offset:128 lds
    v_mfma_f32_32x32x16_bf16 v[224:239], v[188:191], v[248:251], v[224:239]
    ds_read_u16_d16_hi v222, v62 offset:65280
    s_lshl_b32 s78, s7, 5
    v_add_u32 v58, 16, v5
    v_add_u32 v59, 32, v5
    s_add_u32 m0, s68, 114432
    s_nop 0
    buffer_load_dwordx4 v32, s[48:51], s15 offen offset:256 lds
    v_cmp_gt_u32 vcc, 16, v5
    s_nop 1
    v_cndmask_b32 v59, v59, v5, vcc
    s_cmp_ge_u32 s3, 4
    s_cselect_b64 vcc, -1, 0
    v_cndmask_b32 v58, v58, v59, vcc
    s_sub_u32 s78, s78, 16
    v_add_u32 v59, s78, v58
    v_mov_b32 v60, 1000
    s_add_u32 m0, s68, 122496
    s_nop 0
    buffer_load_dwordx4 v32, s[48:51], s15 offen offset:384 lds
    v_cmp_lt_u32 vcc, v59, v60
    s_nop 1
    v_cndmask_b32 v60, 0, 1.0, vcc
    v_lshlrev_b32 v58, 2, v58
    v_mov_b32 v59, 2176
    v_mad_u32_u24 v58, v6, v59, v58
    s_and_b32 s78, s3, 3
    s_add_u32 m0, s68, 102400
    s_add_u32 s15, s71, 196608
    buffer_load_dwordx4 v32, s[48:51], s15 offen lds
    s_mul_i32 s79, s78, 4352
    v_add_u32 v58, s79, v58
    s_lshr_b32 s78, s3, 2
    s_lshl_b32 s78, s78, 14
    v_add_u32 v61, s78, v1
    s_add_u32 m0, s68, 110464
    s_nop 0
    buffer_load_dwordx4 v32, s[48:51], s15 offen offset:128 lds
    s_add_u32 m0, s68, 118528
    s_nop 0
    buffer_load_dwordx4 v32, s[48:51], s15 offen offset:256 lds
    s_add_u32 m0, s68, 126592
    s_nop 0
    buffer_load_dwordx4 v32, s[48:51], s15 offen offset:384 lds
    s_branch L_36
L_33:
    s_cmp_eq_u32 s3, 0
    s_cbranch_scc1 L_37
    v_mov_b32 v248, 0x3f803f80
    v_mov_b32 v249, 0x3f803f80
    v_mov_b32 v250, 0x3f803f80
    v_mov_b32 v251, 0x3f803f80
    v_lshlrev_b32 v62, 1, v0
    v_mov_b32 v192, 0
    v_mov_b32 v193, 0
    v_mfma_f32_32x32x16_bf16 v[224:239], v[128:131], v[248:251], 0
    ds_read_u16_d16_hi v192, v62 offset:61440
    ds_read_u16_d16_hi v193, v62 offset:61568
    v_mov_b32 v194, 0
    v_mov_b32 v195, 0
    v_mfma_f32_32x32x16_bf16 v[224:239], v[132:135], v[248:251], v[224:239]
    ds_read_u16_d16_hi v194, v62 offset:61696
    ds_read_u16_d16_hi v195, v62 offset:61824
    v_mov_b32 v196, 0
    v_mov_b32 v197, 0
    v_mfma_f32_32x32x16_bf16 v[224:239], v[136:139], v[248:251], v[224:239]
    ds_read_u16_d16_hi v196, v62 offset:61952
    ds_read_u16_d16_hi v197, v62 offset:62080
    v_mov_b32 v198, 0
    v_mov_b32 v199, 0
    v_mfma_f32_32x32x16_bf16 v[224:239], v[140:143], v[248:251], v[224:239]
    ds_read_u16_d16_hi v198, v62 offset:62208
    ds_read_u16_d16_hi v199, v62 offset:62336
    v_mov_b32 v200, 0
    v_mov_b32 v201, 0
    v_mfma_f32_32x32x16_bf16 v[224:239], v[144:147], v[248:251], v[224:239]
    s_waitcnt lgkmcnt(6)
    ds_read_u16_d16_hi v200, v62 offset:62464
    ds_read_u16_d16_hi v201, v62 offset:62592
    v_mov_b32 v202, 0
    v_mov_b32 v203, 0
    v_mfma_f32_32x32x16_bf16 v[224:239], v[148:151], v[248:251], v[224:239]
    ds_read_u16_d16_hi v202, v62 offset:62720
    ds_read_u16_d16_hi v203, v62 offset:62848
    v_mov_b32 v204, 0
    v_mov_b32 v205, 0
    v_mfma_f32_32x32x16_bf16 v[224:239], v[152:155], v[248:251], v[224:239]
    ds_read_u16_d16_hi v204, v62 offset:62976
    ds_read_u16_d16_hi v205, v62 offset:63104
    v_mov_b32 v206, 0
    v_mov_b32 v207, 0
    v_mfma_f32_32x32x16_bf16 v[224:239], v[156:159], v[248:251], v[224:239]
    ds_read_u16_d16_hi v206, v62 offset:63232
    ds_read_u16_d16_hi v207, v62 offset:63360
    v_mov_b32 v208, 0
    v_mov_b32 v209, 0
    v_mfma_f32_32x32x16_bf16 v[224:239], v[160:163], v[248:251], v[224:239]
    s_waitcnt lgkmcnt(6)
    ds_read_u16_d16_hi v208, v62 offset:63488
    ds_read_u16_d16_hi v209, v62 offset:63616
    v_mov_b32 v210, 0
    v_mov_b32 v211, 0
    v_mfma_f32_32x32x16_bf16 v[224:239], v[164:167], v[248:251], v[224:239]
    ds_read_u16_d16_hi v210, v62 offset:63744
    ds_read_u16_d16_hi v211, v62 offset:63872
    v_mov_b32 v212, 0
    v_mov_b32 v213, 0
    v_mfma_f32_32x32x16_bf16 v[224:239], v[168:171], v[248:251], v[224:239]
    ds_read_u16_d16_hi v212, v62 offset:64000
    ds_read_u16_d16_hi v213, v62 offset:64128
    v_mov_b32 v214, 0
    v_mov_b32 v215, 0
    v_mfma_f32_32x32x16_bf16 v[224:239], v[172:175], v[248:251], v[224:239]
    ds_read_u16_d16_hi v214, v62 offset:64256
    ds_read_u16_d16_hi v215, v62 offset:64384
    v_mov_b32 v216, 0
    v_mov_b32 v217, 0
    v_mfma_f32_32x32x16_bf16 v[224:239], v[176:179], v[248:251], v[224:239]
    s_waitcnt lgkmcnt(6)
    ds_read_u16_d16_hi v216, v62 offset:64512
    ds_read_u16_d16_hi v217, v62 offset:64640
    v_mov_b32 v218, 0
    v_mov_b32 v219, 0
    v_mfma_f32_32x32x16_bf16 v[224:239], v[180:183], v[248:251], v[224:239]
    ds_read_u16_d16_hi v218, v62 offset:64768
    ds_read_u16_d16_hi v219, v62 offset:64896
    v_mov_b32 v220, 0
    v_mov_b32 v221, 0
    v_mfma_f32_32x32x16_bf16 v[224:239], v[184:187], v[248:251], v[224:239]
    ds_read_u16_d16_hi v220, v62 offset:65024
    ds_read_u16_d16_hi v221, v62 offset:65152
    v_mov_b32 v222, 0
    v_mov_b32 v223, 0
    v_mfma_f32_32x32x16_bf16 v[224:239], v[188:191], v[248:251], v[224:239]
    ds_read_u16_d16_hi v222, v62 offset:65280
    s_lshl_b32 s78, s7, 5
    v_add_u32 v58, 16, v5
    v_add_u32 v59, 32, v5
    v_cmp_gt_u32 vcc, 16, v5
    s_nop 1
    v_cndmask_b32 v59, v59, v5, vcc
    s_cmp_ge_u32 s3, 4
    s_cselect_b64 vcc, -1, 0
    v_cndmask_b32 v58, v58, v59, vcc
    s_sub_u32 s78, s78, 16
    v_add_u32 v59, s78, v58
    v_mov_b32 v60, 1000
    v_cmp_lt_u32 vcc, v59, v60
    s_nop 1
    v_cndmask_b32 v60, 0, 1.0, vcc
    v_lshlrev_b32 v58, 2, v58
    v_mov_b32 v59, 2176
    v_mad_u32_u24 v58, v6, v59, v58
    s_and_b32 s78, s3, 3
    s_mul_i32 s79, s78, 4352
    v_add_u32 v58, s79, v58
    s_lshr_b32 s78, s3, 2
    s_lshl_b32 s78, s78, 14
    v_add_u32 v61, s78, v1
    s_nop 1
    s_branch L_36
L_37:
    buffer_load_dwordx2 v[120:121], v56, s[64:67], s76 offen sc1
    s_sleep 2
    buffer_load_dwordx2 v[122:123], v56, s[64:67], s76 offen sc1
    s_sleep 2
    buffer_load_dwordx2 v[124:125], v56, s[64:67], s76 offen sc1
    s_sleep 2
L_35:
    buffer_load_dwordx2 v[126:127], v56, s[64:67], s76 offen sc1
    s_waitcnt vmcnt(3)
    v_cmp_ne_u64 vcc, s[12:13], v[120:121]
    s_nop 4
    s_cbranch_vccz L_36
    s_sleep 1
    buffer_load_dwordx2 v[120:121], v56, s[64:67], s76 offen sc1
    s_waitcnt vmcnt(3)
    v_cmp_ne_u64 vcc, s[12:13], v[122:123]
    s_nop 4
    s_cbranch_vccz L_36
    s_sleep 1
    buffer_load_dwordx2 v[122:123], v56, s[64:67], s76 offen sc1
    s_waitcnt vmcnt(3)
    v_cmp_ne_u64 vcc, s[12:13], v[124:125]
    s_nop 4
    s_cbranch_vccz L_36
    s_sleep 1
    buffer_load_dwordx2 v[124:125], v56, s[64:67], s76 offen sc1
    s_waitcnt vmcnt(3)
    v_cmp_ne_u64 vcc, s[12:13], v[126:127]
    s_nop 4
    s_cbranch_vccz L_36
    s_sleep 1
    s_add_u32 s99, s99, 1
    s_cmp_lt_u32 s99, 0x10000
    s_cbranch_scc1 L_35
L_36:
    s_mov_b64 exec, -1
    s_barrier
    s_add_u32 s14, s72, 5242880
    buffer_load_dwordx4 v[64:67], v1, s[64:67], s14 offen sc1
    buffer_load_dwordx4 v[68:71], v1, s[64:67], s14 offen offset:1024 sc1
    s_add_u32 s14, s72, 5259264
    buffer_load_dwordx4 v[72:75], v1, s[64:67], s14 offen sc1
    buffer_load_dwordx4 v[76:79], v1, s[64:67], s14 offen offset:1024 sc1
    s_add_u32 s14, s72, 5275648
    buffer_load_dwordx4 v[80:83], v1, s[64:67], s14 offen sc1
    buffer_load_dwordx4 v[84:87], v1, s[64:67], s14 offen offset:1024 sc1
    s_add_u32 s14, s72, 5292032
    buffer_load_dwordx4 v[88:91], v1, s[64:67], s14 offen sc1
    buffer_load_dwordx4 v[92:95], v1, s[64:67], s14 offen offset:1024 sc1
    s_add_u32 s14, s72, 5177344
    buffer_load_dwordx4 v[96:99], v57, s[64:67], s14 offen sc1
    buffer_load_dwordx4 v[100:103], v57, s[64:67], s14 offen offset:1024 sc1
    s_add_u32 s14, s72, 5193728
    buffer_load_dwordx4 v[104:107], v57, s[64:67], s14 offen sc1
    buffer_load_dwordx4 v[108:111], v57, s[64:67], s14 offen offset:1024 sc1
    s_add_u32 s14, s72, 5210112
    buffer_load_dwordx4 v[112:115], v57, s[64:67], s14 offen sc1
    buffer_load_dwordx4 v[116:119], v57, s[64:67], s14 offen offset:1024 sc1
    s_add_u32 s14, s72, 5226496
    buffer_load_dwordx4 v[120:123], v57, s[64:67], s14 offen sc1
    buffer_load_dwordx4 v[124:127], v57, s[64:67], s14 offen offset:1024 sc1
    s_cmp_lg_u32 s3, 0
    s_cbranch_scc1 L_38
    v_mov_b32 v248, 0x3f803f80
    v_mov_b32 v249, 0x3f803f80
    v_mov_b32 v250, 0x3f803f80
    v_mov_b32 v251, 0x3f803f80
    v_lshlrev_b32 v62, 1, v0
    v_mov_b32 v192, 0
    v_mov_b32 v193, 0
    v_mfma_f32_32x32x16_bf16 v[224:239], v[128:131], v[248:251], 0
    ds_read_u16_d16_hi v192, v62 offset:61440
    ds_read_u16_d16_hi v193, v62 offset:61568
    v_mov_b32 v194, 0
    v_mov_b32 v195, 0
    v_mfma_f32_32x32x16_bf16 v[224:239], v[132:135], v[248:251], v[224:239]
    ds_read_u16_d16_hi v194, v62 offset:61696
    ds_read_u16_d16_hi v195, v62 offset:61824
    v_mov_b32 v196, 0
    v_mov_b32 v197, 0
    v_mfma_f32_32x32x16_bf16 v[224:239], v[136:139], v[248:251], v[224:239]
    ds_read_u16_d16_hi v196, v62 offset:61952
    ds_read_u16_d16_hi v197, v62 offset:62080
    v_mov_b32 v198, 0
    v_mov_b32 v199, 0
    v_mfma_f32_32x32x16_bf16 v[224:239], v[140:143], v[248:251], v[224:239]
    ds_read_u16_d16_hi v198, v62 offset:62208
    ds_read_u16_d16_hi v199, v62 offset:62336
    v_mov_b32 v200, 0
    v_mov_b32 v201, 0
    v_mfma_f32_32x32x16_bf16 v[224:239], v[144:147], v[248:251], v[224:239]
    s_waitcnt lgkmcnt(6)
    ds_read_u16_d16_hi v200, v62 offset:62464
    ds_read_u16_d16_hi v201, v62 offset:62592
    v_mov_b32 v202, 0
    v_mov_b32 v203, 0
    v_mfma_f32_32x32x16_bf16 v[224:239], v[148:151], v[248:251], v[224:239]
    ds_read_u16_d16_hi v202, v62 offset:62720
    ds_read_u16_d16_hi v203, v62 offset:62848
    v_mov_b32 v204, 0
    v_mov_b32 v205, 0
    v_mfma_f32_32x32x16_bf16 v[224:239], v[152:155], v[248:251], v[224:239]
    ds_read_u16_d16_hi v204, v62 offset:62976
    ds_read_u16_d16_hi v205, v62 offset:63104
    v_mov_b32 v206, 0
    v_mov_b32 v207, 0
    v_mfma_f32_32x32x16_bf16 v[224:239], v[156:159], v[248:251], v[224:239]
    ds_read_u16_d16_hi v206, v62 offset:63232
    ds_read_u16_d16_hi v207, v62 offset:63360
    v_mov_b32 v208, 0
    v_mov_b32 v209, 0
    v_mfma_f32_32x32x16_bf16 v[224:239], v[160:163], v[248:251], v[224:239]
    s_waitcnt lgkmcnt(6)
    ds_read_u16_d16_hi v208, v62 offset:63488
    ds_read_u16_d16_hi v209, v62 offset:63616
    v_mov_b32 v210, 0
    v_mov_b32 v211, 0
    v_mfma_f32_32x32x16_bf16 v[224:239], v[164:167], v[248:251], v[224:239]
    ds_read_u16_d16_hi v210, v62 offset:63744
    ds_read_u16_d16_hi v211, v62 offset:63872
    v_mov_b32 v212, 0
    v_mov_b32 v213, 0
    v_mfma_f32_32x32x16_bf16 v[224:239], v[168:171], v[248:251], v[224:239]
    ds_read_u16_d16_hi v212, v62 offset:64000
    ds_read_u16_d16_hi v213, v62 offset:64128
    v_mov_b32 v214, 0
    v_mov_b32 v215, 0
    v_mfma_f32_32x32x16_bf16 v[224:239], v[172:175], v[248:251], v[224:239]
    ds_read_u16_d16_hi v214, v62 offset:64256
    ds_read_u16_d16_hi v215, v62 offset:64384
    v_mov_b32 v216, 0
    v_mov_b32 v217, 0
    v_mfma_f32_32x32x16_bf16 v[224:239], v[176:179], v[248:251], v[224:239]
    s_waitcnt lgkmcnt(6)
    ds_read_u16_d16_hi v216, v62 offset:64512
    ds_read_u16_d16_hi v217, v62 offset:64640
    v_mov_b32 v218, 0
    v_mov_b32 v219, 0
    v_mfma_f32_32x32x16_bf16 v[224:239], v[180:183], v[248:251], v[224:239]
    ds_read_u16_d16_hi v218, v62 offset:64768
    ds_read_u16_d16_hi v219, v62 offset:64896
    v_mov_b32 v220, 0
    v_mov_b32 v221, 0
    v_mfma_f32_32x32x16_bf16 v[224:239], v[184:187], v[248:251], v[224:239]
    ds_read_u16_d16_hi v220, v62 offset:65024
    ds_read_u16_d16_hi v221, v62 offset:65152
    v_mov_b32 v222, 0
    v_mov_b32 v223, 0
    v_mfma_f32_32x32x16_bf16 v[224:239], v[188:191], v[248:251], v[224:239]
    ds_read_u16_d16_hi v222, v62 offset:65280
    s_lshl_b32 s78, s7, 5
    v_add_u32 v58, 16, v5
    v_add_u32 v59, 32, v5
    v_cmp_gt_u32 vcc, 16, v5
    s_nop 1
    v_cndmask_b32 v59, v59, v5, vcc
    s_cmp_ge_u32 s3, 4
    s_cselect_b64 vcc, -1, 0
    v_cndmask_b32 v58, v58, v59, vcc
    s_sub_u32 s78, s78, 16
    v_add_u32 v59, s78, v58
    v_mov_b32 v60, 1000
    v_cmp_lt_u32 vcc, v59, v60
    s_nop 1
    v_cndmask_b32 v60, 0, 1.0, vcc
    v_lshlrev_b32 v58, 2, v58
    v_mov_b32 v59, 2176
    v_mad_u32_u24 v58, v6, v59, v58
    s_and_b32 s78, s3, 3
    s_mul_i32 s79, s78, 4352
    v_add_u32 v58, s79, v58
    s_lshr_b32 s78, s3, 2
    s_lshl_b32 s78, s78, 14
    v_add_u32 v61, s78, v1
    s_nop 1
L_38:
    s_waitcnt vmcnt(14)
    v_mfma_f32_32x32x16_bf16 v[16:31], v[8:11], v[64:67], 0
    v_mfma_f32_32x32x16_bf16 v[16:31], v[12:15], v[68:71], v[16:31]
    s_waitcnt vmcnt(12)
    v_mfma_f32_32x32x16_bf16 v[16:31], v[8:11], v[72:75], v[16:31]
    v_mfma_f32_32x32x16_bf16 v[16:31], v[12:15], v[76:79], v[16:31]
    s_waitcnt vmcnt(10)
    v_mfma_f32_32x32x16_bf16 v[16:31], v[8:11], v[80:83], v[16:31]
    v_mfma_f32_32x32x16_bf16 v[16:31], v[12:15], v[84:87], v[16:31]
    s_waitcnt vmcnt(8)
    v_mfma_f32_32x32x16_bf16 v[16:31], v[8:11], v[88:91], v[16:31]
    v_mfma_f32_32x32x16_bf16 v[16:31], v[12:15], v[92:95], v[16:31]
    s_waitcnt vmcnt(6)
    v_mfma_f32_32x32x16_bf16 v[40:55], v[8:11], v[96:99], 0
    v_mfma_f32_32x32x16_bf16 v[40:55], v[12:15], v[100:103], v[40:55]
    s_waitcnt vmcnt(4)
    v_mfma_f32_32x32x16_bf16 v[40:55], v[8:11], v[104:107], v[40:55]
    v_mfma_f32_32x32x16_bf16 v[40:55], v[12:15], v[108:111], v[40:55]
    s_waitcnt vmcnt(2)
    v_mfma_f32_32x32x16_bf16 v[40:55], v[8:11], v[112:115], v[40:55]
    v_mfma_f32_32x32x16_bf16 v[40:55], v[12:15], v[116:119], v[40:55]
    s_waitcnt vmcnt(0)
    v_mfma_f32_32x32x16_bf16 v[40:55], v[8:11], v[120:123], v[40:55]
    v_mfma_f32_32x32x16_bf16 v[40:55], v[12:15], v[124:127], v[40:55]
    v_add_u32 v72, s69, v1
    v_cvt_pk_bf16_f32 v80, v16, v17
    v_cvt_pk_bf16_f32 v81, v18, v19
    v_cvt_pk_bf16_f32 v82, v20, v21
    v_cvt_pk_bf16_f32 v83, v22, v23
    v_cvt_pk_bf16_f32 v84, v24, v25
    v_cvt_pk_bf16_f32 v85, v26, v27
    v_cvt_pk_bf16_f32 v86, v28, v29
    v_cvt_pk_bf16_f32 v87, v30, v31
    ds_write_b128 v72, v[80:83] offset:0
    ds_write_b128 v72, v[84:87] offset:1024
    s_nop 0
    v_cvt_pk_bf16_f32 v88, v40, v41
    v_cvt_pk_bf16_f32 v89, v42, v43
    v_cvt_pk_bf16_f32 v90, v44, v45
    v_cvt_pk_bf16_f32 v91, v46, v47
    v_cvt_pk_bf16_f32 v92, v48, v49
    v_cvt_pk_bf16_f32 v93, v50, v51
    v_cvt_pk_bf16_f32 v94, v52, v53
    v_cvt_pk_bf16_f32 v95, v54, v55
    ds_write_b128 v72, v[88:91] offset:16384
    ds_write_b128 v72, v[92:95] offset:17408
    v_pk_add_f32 v[64:65], v[16:17], v[18:19]
    v_pk_mul_f32 v[66:67], v[16:17], v[16:17]
    v_pk_fma_f32 v[66:67], v[18:19], v[18:19], v[66:67]
    v_pk_add_f32 v[64:65], v[64:65], v[20:21]
    v_pk_fma_f32 v[66:67], v[20:21], v[20:21], v[66:67]
    v_pk_add_f32 v[64:65], v[64:65], v[22:23]
    v_pk_fma_f32 v[66:67], v[22:23], v[22:23], v[66:67]
    v_pk_add_f32 v[64:65], v[64:65], v[24:25]
    v_pk_fma_f32 v[66:67], v[24:25], v[24:25], v[66:67]
    v_pk_add_f32 v[64:65], v[64:65], v[26:27]
    v_pk_fma_f32 v[66:67], v[26:27], v[26:27], v[66:67]
    v_pk_add_f32 v[64:65], v[64:65], v[28:29]
    v_pk_fma_f32 v[66:67], v[28:29], v[28:29], v[66:67]
    v_pk_add_f32 v[64:65], v[64:65], v[30:31]
    v_pk_fma_f32 v[66:67], v[30:31], v[30:31], v[66:67]
    v_add_f32 v64, v64, v65
    v_add_f32 v66, v66, v67
    s_nop 1
    v_permlane32_swap_b32 v64, v66
    v_add_f32 v64, v64, v66
    v_pk_add_f32 v[68:69], v[40:41], v[42:43]
    v_pk_mul_f32 v[70:71], v[40:41], v[40:41]
    v_pk_fma_f32 v[70:71], v[42:43], v[42:43], v[70:71]
    v_pk_add_f32 v[68:69], v[68:69], v[44:45]
    v_pk_fma_f32 v[70:71], v[44:45], v[44:45], v[70:71]
    v_pk_add_f32 v[68:69], v[68:69], v[46:47]
    v_pk_fma_f32 v[70:71], v[46:47], v[46:47], v[70:71]
    v_pk_add_f32 v[68:69], v[68:69], v[48:49]
    v_pk_fma_f32 v[70:71], v[48:49], v[48:49], v[70:71]
    v_pk_add_f32 v[68:69], v[68:69], v[50:51]
    v_pk_fma_f32 v[70:71], v[50:51], v[50:51], v[70:71]
    v_pk_add_f32 v[68:69], v[68:69], v[52:53]
    v_pk_fma_f32 v[70:71], v[52:53], v[52:53], v[70:71]
    v_pk_add_f32 v[68:69], v[68:69], v[54:55]
    v_pk_fma_f32 v[70:71], v[54:55], v[54:55], v[70:71]
    v_add_f32 v68, v68, v69
    v_add_f32 v70, v70, v71
    s_nop 1
    v_permlane32_swap_b32 v68, v70
    v_add_f32 v68, v68, v70
    s_lshl_b32 s14, s3, 2
    v_lshlrev_b32 v7, 1, v1
    v_add_u32 v65, s14, v7
    ds_write_b32 v65, v64 offset:32768
    ds_write_b32 v65, v68 offset:34816
    s_lshr_b32 s14, s3, 2
    s_lshl_b32 s14, s14, 11
    v_add_u32 v7, s14, v7
    s_waitcnt lgkmcnt(0)
    s_barrier
    ds_read_b128 v[240:243], v7 offset:32768
    ds_read_b128 v[244:247], v7 offset:32784
    v_lshlrev_b32 v33, 7, v0
    s_mul_i32 s15, s98, 2048
    s_mov_b64 exec, 65535
    buffer_load_dword v63, v33, s[52:55], s15 offen sc1
    s_mov_b64 exec, -1
    ds_read_b128 v[64:67], v61 offset:0
    ds_read_b128 v[68:71], v61 offset:1024
    ds_read_b128 v[72:75], v61 offset:2048
    ds_read_b128 v[76:79], v61 offset:3072
    ds_read_b128 v[80:83], v61 offset:4096
    ds_read_b128 v[84:87], v61 offset:5120
    ds_read_b128 v[88:91], v61 offset:6144
    ds_read_b128 v[92:95], v61 offset:7168
    ds_read_b128 v[96:99], v61 offset:8192
    ds_read_b128 v[100:103], v61 offset:9216
    ds_read_b128 v[104:107], v61 offset:10240
    ds_read_b128 v[108:111], v61 offset:11264
    s_waitcnt lgkmcnt(10)
    v_mfma_f32_32x32x16_bf16 v[40:55], v[128:131], v[64:67], 0
    v_mfma_f32_32x32x16_bf16 v[40:55], v[132:135], v[68:71], v[40:55]
    ds_read_b128 v[64:67], v61 offset:12288
    s_waitcnt lgkmcnt(9)
    v_mfma_f32_32x32x16_bf16 v[40:55], v[136:139], v[72:75], v[40:55]
    ds_read_b128 v[68:71], v61 offset:13312
    v_mfma_f32_32x32x16_bf16 v[40:55], v[140:143], v[76:79], v[40:55]
    ds_read_b128 v[72:75], v61 offset:14336
    s_waitcnt lgkmcnt(9)
    v_mfma_f32_32x32x16_bf16 v[40:55], v[144:147], v[80:83], v[40:55]
    ds_read_b128 v[76:79], v61 offset:15360
    v_mfma_f32_32x32x16_bf16 v[40:55], v[148:151], v[84:87], v[40:55]
    v_pk_add_f32 v[240:241], v[240:241], v[242:243]
    v_pk_add_f32 v[244:245], v[244:245], v[246:247]
    v_pk_add_f32 v[240:241], v[240:241], v[244:245]
    v_add_f32 v240, v240, v241
    v_mul_f32 v240, 0x3b800000, v240
    v_mov_b32 v241, v240
    s_nop 1
    v_permlane32_swap_b32 v240, v241
    v_fma_f32 v241, -v240, v240, v241
    v_max_f32 v241, 0, v241
    v_add_f32 v241, 0x3727c5ac, v241
    v_rsq_f32 v242, v241
    s_nop 0
    v_mul_f32 v244, -v240, v242
    v_pk_mul_f32 v[224:225], v[224:225], v[244:245] op_sel_hi:[1,0]
    v_pk_mul_f32 v[226:227], v[226:227], v[244:245] op_sel_hi:[1,0]
    v_pk_mul_f32 v[228:229], v[228:229], v[244:245] op_sel_hi:[1,0]
    v_pk_mul_f32 v[230:231], v[230:231], v[244:245] op_sel_hi:[1,0]
    v_pk_mul_f32 v[232:233], v[232:233], v[244:245] op_sel_hi:[1,0]
    v_pk_mul_f32 v[234:235], v[234:235], v[244:245] op_sel_hi:[1,0]
    v_pk_mul_f32 v[236:237], v[236:237], v[244:245] op_sel_hi:[1,0]
    v_pk_mul_f32 v[238:239], v[238:239], v[244:245] op_sel_hi:[1,0]
    s_waitcnt lgkmcnt(8)
    v_mfma_f32_32x32x16_bf16 v[40:55], v[152:155], v[88:91], v[40:55]
    v_mfma_f32_32x32x16_bf16 v[40:55], v[156:159], v[92:95], v[40:55]
    s_waitcnt lgkmcnt(6)
    v_mfma_f32_32x32x16_bf16 v[40:55], v[160:163], v[96:99], v[40:55]
    v_mfma_f32_32x32x16_bf16 v[40:55], v[164:167], v[100:103], v[40:55]
    s_waitcnt lgkmcnt(4)
    v_mfma_f32_32x32x16_bf16 v[40:55], v[168:171], v[104:107], v[40:55]
    v_mfma_f32_32x32x16_bf16 v[40:55], v[172:175], v[108:111], v[40:55]
    s_waitcnt lgkmcnt(2)
    v_mfma_f32_32x32x16_bf16 v[40:55], v[176:179], v[64:67], v[40:55]
    v_mfma_f32_32x32x16_bf16 v[40:55], v[180:183], v[68:71], v[40:55]
    s_waitcnt lgkmcnt(0)
    v_mfma_f32_32x32x16_bf16 v[40:55], v[184:187], v[72:75], v[40:55]
    v_mfma_f32_32x32x16_bf16 v[40:55], v[188:191], v[76:79], v[40:55]
    ds_read_b64_tr_b16 v[128:129], v37 offset:32768
    ds_read_b64_tr_b16 v[130:131], v37 offset:33280
    ds_read_b64_tr_b16 v[132:133], v37 offset:34816
    ds_read_b64_tr_b16 v[134:135], v37 offset:35328
    ds_read_b64_tr_b16 v[136:137], v37 offset:36864
    ds_read_b64_tr_b16 v[138:139], v37 offset:37376
    ds_read_b64_tr_b16 v[140:141], v37 offset:38912
    ds_read_b64_tr_b16 v[142:143], v37 offset:39424
    s_waitcnt lgkmcnt(6)
    ds_read_b64_tr_b16 v[144:145], v38 offset:0
    ds_read_b64_tr_b16 v[146:147], v38 offset:512
    ds_read_b64_tr_b16 v[148:149], v38 offset:2048
    ds_read_b64_tr_b16 v[150:151], v38 offset:2560
    ds_read_b64_tr_b16 v[152:153], v38 offset:4096
    ds_read_b64_tr_b16 v[154:155], v38 offset:4608
    ds_read_b64_tr_b16 v[156:157], v38 offset:6144
    ds_read_b64_tr_b16 v[158:159], v38 offset:6656
    v_pk_fma_f32 v[40:41], v[40:41], v[242:243], v[224:225] op_sel_hi:[1,0,1]
    v_pk_fma_f32 v[42:43], v[42:43], v[242:243], v[226:227] op_sel_hi:[1,0,1]
    v_pk_fma_f32 v[44:45], v[44:45], v[242:243], v[228:229] op_sel_hi:[1,0,1]
    v_pk_fma_f32 v[46:47], v[46:47], v[242:243], v[230:231] op_sel_hi:[1,0,1]
    v_pk_fma_f32 v[48:49], v[48:49], v[242:243], v[232:233] op_sel_hi:[1,0,1]
    v_pk_fma_f32 v[50:51], v[50:51], v[242:243], v[234:235] op_sel_hi:[1,0,1]
    v_pk_fma_f32 v[52:53], v[52:53], v[242:243], v[236:237] op_sel_hi:[1,0,1]
    v_pk_fma_f32 v[54:55], v[54:55], v[242:243], v[238:239] op_sel_hi:[1,0,1]
    s_mov_b32 s14, 0xbfb8aa3b
    s_mov_b32 s15, 0xbfb8aa3b
    v_pk_mul_f32 v[48:49], v[48:49], s[14:15]
    v_pk_mul_f32 v[50:51], v[50:51], s[14:15]
    v_pk_mul_f32 v[52:53], v[52:53], s[14:15]
    v_pk_mul_f32 v[54:55], v[54:55], s[14:15]
    v_exp_f32 v48, v48
    v_exp_f32 v49, v49
    v_exp_f32 v50, v50
    v_exp_f32 v51, v51
    v_exp_f32 v52, v52
    v_exp_f32 v53, v53
    v_exp_f32 v54, v54
    v_exp_f32 v55, v55
    v_pk_mul_f32 v[40:41], v[40:41], v[60:61] op_sel_hi:[1,0]
    v_pk_mul_f32 v[42:43], v[42:43], v[60:61] op_sel_hi:[1,0]
    v_pk_mul_f32 v[44:45], v[44:45], v[60:61] op_sel_hi:[1,0]
    v_pk_mul_f32 v[46:47], v[46:47], v[60:61] op_sel_hi:[1,0]
    v_pk_add_f32 v[48:49], v[48:49], 1.0 op_sel_hi:[1,0]
    v_pk_add_f32 v[50:51], v[50:51], 1.0 op_sel_hi:[1,0]
    v_pk_add_f32 v[52:53], v[52:53], 1.0 op_sel_hi:[1,0]
    v_pk_add_f32 v[54:55], v[54:55], 1.0 op_sel_hi:[1,0]
    v_rcp_f32 v48, v48
    v_rcp_f32 v49, v49
    v_rcp_f32 v50, v50
    v_rcp_f32 v51, v51
    v_rcp_f32 v52, v52
    v_rcp_f32 v53, v53
    v_rcp_f32 v54, v54
    v_rcp_f32 v55, v55
    v_pk_mul_f32 v[40:41], v[40:41], v[48:49]
    v_pk_mul_f32 v[42:43], v[42:43], v[50:51]
    v_pk_mul_f32 v[44:45], v[44:45], v[52:53]
    v_pk_mul_f32 v[46:47], v[46:47], v[54:55]
    ds_write_b32 v58, v40 offset:36876
    ds_write_b32 v58, v41 offset:37148
    ds_write_b32 v58, v42 offset:37420
    ds_write_b32 v58, v43 offset:37692
    ds_write_b32 v58, v44 offset:37964
    ds_write_b32 v58, v45 offset:38236
    ds_write_b32 v58, v46 offset:38508
    ds_write_b32 v58, v47 offset:38780
    s_lshl_b32 s14, s3, 4
    v_mul_u32_u24 v58, 272, v0
    v_add_u32 v58, s14, v58
    v_mul_u32_u24 v32, 2048, v3
    v_add_u32 v32, v32, v4
    s_lshl_b32 s71, s3, 14
    s_lshl_b32 s14, s5, 9
    s_add_u32 s71, s71, s14
    s_waitcnt lgkmcnt(0)
    s_barrier
    ds_read_b128 v[64:67], v58 offset:36880
    ds_read_b128 v[68:71], v58 offset:36896
    ds_read_b128 v[72:75], v58 offset:36912
    ds_read_b128 v[76:79], v58 offset:36928
    ds_read_b128 v[80:83], v58 offset:36944
    ds_read_b128 v[84:87], v58 offset:36960
    ds_read_b128 v[88:91], v58 offset:36976
    ds_read_b128 v[92:95], v58 offset:36992
    ds_read_b128 v[96:99], v58 offset:37008
    v_mov_b32 v224, 0
    v_mov_b32 v225, v192
    v_mov_b32 v226, v193
    v_mov_b32 v227, v194
    v_mov_b32 v228, v195
    v_mov_b32 v229, v196
    v_mov_b32 v230, v197
    v_mov_b32 v231, v198
    v_mov_b32 v232, v199
    v_mov_b32 v233, v200
    v_mov_b32 v234, v201
    v_mov_b32 v235, v202
    v_mov_b32 v236, v203
    v_mov_b32 v237, v204
    v_mov_b32 v238, v205
    v_mov_b32 v239, v206
    v_mov_b32 v240, v207
    v_mov_b32 v241, v208
    v_mov_b32 v242, v209
    v_mov_b32 v243, v210
    v_mov_b32 v244, v211
    v_mov_b32 v245, v212
    v_mov_b32 v246, v213
    v_mov_b32 v247, v214
    v_mov_b32 v248, v215
    v_mov_b32 v249, v216
    v_mov_b32 v250, v217
    v_mov_b32 v251, v218
    v_mov_b32 v252, v219
    v_mov_b32 v253, v220
    v_mov_b32 v254, v221
    v_mov_b32 v255, v222
    s_add_u32 m0, s11, 65536
    s_add_u32 s15, s71, 262144
    buffer_load_dwordx4 v32, s[48:51], s15 offen lds
    s_waitcnt lgkmcnt(8)
    v_pk_mul_f32 v[40:41], v[64:65], v[192:193]
    v_pk_mul_f32 v[42:43], v[64:65], v[224:225]
    v_pk_mul_f32 v[44:45], v[66:67], v[192:193]
    v_pk_mul_f32 v[46:47], v[66:67], v[224:225]
    s_waitcnt lgkmcnt(7)
    v_pk_fma_f32 v[40:41], v[66:67], v[194:195], v[40:41]
    v_pk_fma_f32 v[42:43], v[66:67], v[226:227], v[42:43]
    v_pk_fma_f32 v[44:45], v[68:69], v[194:195], v[44:45]
    v_pk_fma_f32 v[46:47], v[68:69], v[226:227], v[46:47]
    s_add_u32 m0, s11, 73600
    s_add_u32 s15, s71, 262144
    buffer_load_dwordx4 v32, s[48:51], s15 offen offset:128 lds
    v_pk_fma_f32 v[40:41], v[68:69], v[196:197], v[40:41]
    v_pk_fma_f32 v[42:43], v[68:69], v[228:229], v[42:43]
    v_pk_fma_f32 v[44:45], v[70:71], v[196:197], v[44:45]
    v_pk_fma_f32 v[46:47], v[70:71], v[228:229], v[46:47]
    s_waitcnt lgkmcnt(6)
    v_pk_fma_f32 v[40:41], v[70:71], v[198:199], v[40:41]
    v_pk_fma_f32 v[42:43], v[70:71], v[230:231], v[42:43]
    v_pk_fma_f32 v[44:45], v[72:73], v[198:199], v[44:45]
    v_pk_fma_f32 v[46:47], v[72:73], v[230:231], v[46:47]
    s_add_u32 m0, s11, 81664
    s_add_u32 s15, s71, 262144
    buffer_load_dwordx4 v32, s[48:51], s15 offen offset:256 lds
    v_pk_fma_f32 v[40:41], v[72:73], v[200:201], v[40:41]
    v_pk_fma_f32 v[42:43], v[72:73], v[232:233], v[42:43]
    v_pk_fma_f32 v[44:45], v[74:75], v[200:201], v[44:45]
    v_pk_fma_f32 v[46:47], v[74:75], v[232:233], v[46:47]
    s_waitcnt lgkmcnt(5)
    v_pk_fma_f32 v[40:41], v[74:75], v[202:203], v[40:41]
    v_pk_fma_f32 v[42:43], v[74:75], v[234:235], v[42:43]
    v_pk_fma_f32 v[44:45], v[76:77], v[202:203], v[44:45]
    v_pk_fma_f32 v[46:47], v[76:77], v[234:235], v[46:47]
    s_add_u32 m0, s11, 89728
    s_add_u32 s15, s71, 262144
    buffer_load_dwordx4 v32, s[48:51], s15 offen offset:384 lds
    v_pk_fma_f32 v[40:41], v[76:77], v[204:205], v[40:41]
    v_pk_fma_f32 v[42:43], v[76:77], v[236:237], v[42:43]
    v_pk_fma_f32 v[44:45], v[78:79], v[204:205], v[44:45]
    v_pk_fma_f32 v[46:47], v[78:79], v[236:237], v[46:47]
    s_waitcnt lgkmcnt(4)
    v_pk_fma_f32 v[40:41], v[78:79], v[206:207], v[40:41]
    v_pk_fma_f32 v[42:43], v[78:79], v[238:239], v[42:43]
    v_pk_fma_f32 v[44:45], v[80:81], v[206:207], v[44:45]
    v_pk_fma_f32 v[46:47], v[80:81], v[238:239], v[46:47]
    s_add_u32 m0, s11, 98304
    s_add_u32 s15, s71, 393216
    buffer_load_dwordx4 v32, s[48:51], s15 offen lds
    v_pk_fma_f32 v[40:41], v[80:81], v[208:209], v[40:41]
    v_pk_fma_f32 v[42:43], v[80:81], v[240:241], v[42:43]
    v_pk_fma_f32 v[44:45], v[82:83], v[208:209], v[44:45]
    v_pk_fma_f32 v[46:47], v[82:83], v[240:241], v[46:47]
    s_waitcnt lgkmcnt(3)
    v_pk_fma_f32 v[40:41], v[82:83], v[210:211], v[40:41]
    v_pk_fma_f32 v[42:43], v[82:83], v[242:243], v[42:43]
    v_pk_fma_f32 v[44:45], v[84:85], v[210:211], v[44:45]
    v_pk_fma_f32 v[46:47], v[84:85], v[242:243], v[46:47]
    s_add_u32 m0, s11, 106368
    s_add_u32 s15, s71, 393216
    buffer_load_dwordx4 v32, s[48:51], s15 offen offset:128 lds
    v_pk_fma_f32 v[40:41], v[84:85], v[212:213], v[40:41]
    v_pk_fma_f32 v[42:43], v[84:85], v[244:245], v[42:43]
    v_pk_fma_f32 v[44:45], v[86:87], v[212:213], v[44:45]
    v_pk_fma_f32 v[46:47], v[86:87], v[244:245], v[46:47]
    s_waitcnt lgkmcnt(2)
    v_pk_fma_f32 v[40:41], v[86:87], v[214:215], v[40:41]
    v_pk_fma_f32 v[42:43], v[86:87], v[246:247], v[42:43]
    v_pk_fma_f32 v[44:45], v[88:89], v[214:215], v[44:45]
    v_pk_fma_f32 v[46:47], v[88:89], v[246:247], v[46:47]
    s_add_u32 m0, s11, 114432
    s_add_u32 s15, s71, 393216
    buffer_load_dwordx4 v32, s[48:51], s15 offen offset:256 lds
    v_pk_fma_f32 v[40:41], v[88:89], v[216:217], v[40:41]
    v_pk_fma_f32 v[42:43], v[88:89], v[248:249], v[42:43]
    v_pk_fma_f32 v[44:45], v[90:91], v[216:217], v[44:45]
    v_pk_fma_f32 v[46:47], v[90:91], v[248:249], v[46:47]
    s_waitcnt lgkmcnt(1)
    v_pk_fma_f32 v[40:41], v[90:91], v[218:219], v[40:41]
    v_pk_fma_f32 v[42:43], v[90:91], v[250:251], v[42:43]
    v_pk_fma_f32 v[44:45], v[92:93], v[218:219], v[44:45]
    v_pk_fma_f32 v[46:47], v[92:93], v[250:251], v[46:47]
    s_add_u32 m0, s11, 122496
    s_add_u32 s15, s71, 393216
    buffer_load_dwordx4 v32, s[48:51], s15 offen offset:384 lds
    v_pk_fma_f32 v[40:41], v[92:93], v[220:221], v[40:41]
    v_pk_fma_f32 v[42:43], v[92:93], v[252:253], v[42:43]
    v_pk_fma_f32 v[44:45], v[94:95], v[220:221], v[44:45]
    v_pk_fma_f32 v[46:47], v[94:95], v[252:253], v[46:47]
    s_waitcnt lgkmcnt(0)
    v_pk_fma_f32 v[40:41], v[94:95], v[222:223], v[40:41]
    v_pk_fma_f32 v[42:43], v[94:95], v[254:255], v[42:43]
    v_pk_fma_f32 v[44:45], v[96:97], v[222:223], v[44:45]
    v_pk_fma_f32 v[46:47], v[96:97], v[254:255], v[46:47]
    v_add_f32 v48, v40, v41
    v_add_f32 v49, v42, v43
    v_add_f32 v50, v44, v45
    v_add_f32 v51, v46, v47
    v_mul_f32 v52, 0xbfb8aa3b, v48
    v_mul_f32 v53, 0xbfb8aa3b, v49
    v_mul_f32 v54, 0xbfb8aa3b, v50
    v_mul_f32 v55, 0xbfb8aa3b, v51
    v_exp_f32 v52, v52
    v_exp_f32 v53, v53
    v_exp_f32 v54, v54
    v_exp_f32 v55, v55
    v_lshrrev_b32 v58, 3, v0
    v_lshlrev_b32 v58, 9, v58
    v_and_b32 v59, 7, v0
    v_lshl_add_u32 v58, v59, 1, v58
    s_lshl_b32 s14, s3, 6
    v_add_u32 v58, s14, v58
    v_add_f32 v52, 1.0, v52
    v_add_f32 v53, 1.0, v53
    v_add_f32 v54, 1.0, v54
    v_add_f32 v55, 1.0, v55
    v_rcp_f32 v52, v52
    v_rcp_f32 v53, v53
    v_rcp_f32 v54, v54
    v_rcp_f32 v55, v55
    v_mul_f32 v48, v48, v52
    v_mul_f32 v49, v49, v53
    v_mul_f32 v50, v50, v54
    v_mul_f32 v51, v51, v55
    v_cvt_pk_bf16_f32 v52, v48, v49
    v_cvt_pk_bf16_f32 v53, v50, v51
    ds_write_b16 v58, v52 offset:57344
    ds_write_b16_d16_hi v58, v52 offset:57360
    ds_write_b16 v58, v53 offset:57376
    ds_write_b16_d16_hi v58, v53 offset:57392
    s_waitcnt lgkmcnt(0)
    s_barrier
    ds_read_b64_tr_b16 v[64:65], v38 offset:32768
    ds_read_b64_tr_b16 v[66:67], v38 offset:33280
    ds_read_b128 v[68:71], v1 offset:57344
    ds_read_b64_tr_b16 v[72:73], v38 offset:34816
    ds_read_b64_tr_b16 v[74:75], v38 offset:35328
    ds_read_b128 v[76:79], v1 offset:58368
    ds_read_b64_tr_b16 v[80:81], v38 offset:36864
    ds_read_b64_tr_b16 v[82:83], v38 offset:37376
    ds_read_b128 v[84:87], v1 offset:59392
    ds_read_b64_tr_b16 v[88:89], v38 offset:38912
    ds_read_b64_tr_b16 v[90:91], v38 offset:39424
    ds_read_b128 v[92:95], v1 offset:60416
    s_waitcnt lgkmcnt(6)
    v_mfma_f32_32x32x16_bf16 v[48:63], v[64:67], v[68:71], 0
    v_mfma_f32_32x32x16_bf16 v[48:63], v[72:75], v[76:79], v[48:63]
    s_waitcnt lgkmcnt(0)
    v_mfma_f32_32x32x16_bf16 v[48:63], v[80:83], v[84:87], v[48:63]
    v_mfma_f32_32x32x16_bf16 v[48:63], v[88:91], v[92:95], v[48:63]
    s_nop 11
    v_cvt_pk_bf16_f32 v192, v48, v49
    v_cvt_pk_bf16_f32 v193, v50, v51
    v_cvt_pk_bf16_f32 v194, v52, v53
    v_cvt_pk_bf16_f32 v195, v54, v55
    v_cvt_pk_bf16_f32 v196, v56, v57
    v_cvt_pk_bf16_f32 v197, v58, v59
    v_cvt_pk_bf16_f32 v198, v60, v61
    v_cvt_pk_bf16_f32 v199, v62, v63
    s_add_u32 s14, s73, 9437184
    buffer_store_dwordx4 v[192:195], v1, s[64:67], s14 offen sc1
    buffer_store_dwordx4 v[196:199], v1, s[64:67], s14 offen offset:1024 sc1
    v_pk_add_f32 v[16:17], v[16:17], v[48:49]
    v_pk_add_f32 v[18:19], v[18:19], v[50:51]
    v_pk_add_f32 v[20:21], v[20:21], v[52:53]
    v_pk_add_f32 v[22:23], v[22:23], v[54:55]
    v_pk_add_f32 v[24:25], v[24:25], v[56:57]
    v_pk_add_f32 v[26:27], v[26:27], v[58:59]
    v_pk_add_f32 v[28:29], v[28:29], v[60:61]
    v_pk_add_f32 v[30:31], v[30:31], v[62:63]
    s_lshl_b32 s14, s5, 3
    s_add_u32 s75, s74, s14
    s_add_u32 s75, s75, 196608
    s_add_u32 s76, s74, 196608
    s_waitcnt vmcnt(0) lgkmcnt(0)
    s_barrier
    s_cmp_lg_u32 s3, 0
    s_cbranch_scc1 L_40
    v_mov_b32 v36, 0
    v_mov_b32 v34, s12
    v_mov_b32 v35, s13
    s_mov_b64 exec, 1
    s_lshl_b32 s14, s5, 7
    s_add_u32 s14, s14, s76
    buffer_store_dwordx2 v[34:35], v36, s[64:67], s14 offen offset:128
    s_mov_b64 exec, -1
L_40:
    s_cmp_lt_u32 s3, 4
    s_cbranch_scc1 L_39
    v_mul_u32_u24 v32, 512, v3
    v_add_u32 v32, v32, v4
    s_lshl_b32 s71, s68, 2
    s_lshl_b32 s14, s5, 17
    s_add_u32 s71, s71, s14
    s_add_u32 m0, s68, 32768
    s_add_u32 s15, s71, 0
    buffer_load_dwordx4 v32, s[52:55], s15 offen lds
    ds_read_b64_tr_b16 v[160:161], v37 offset:32768
    ds_read_b64_tr_b16 v[162:163], v37 offset:33280
    ds_read_b64_tr_b16 v[164:165], v37 offset:34816
    s_add_u32 m0, s68, 40832
    s_nop 0
    buffer_load_dwordx4 v32, s[52:55], s15 offen offset:128 lds
    ds_read_b64_tr_b16 v[166:167], v37 offset:35328
    ds_read_b64_tr_b16 v[168:169], v37 offset:36864
    ds_read_b64_tr_b16 v[170:171], v37 offset:37376
    s_add_u32 m0, s68, 48896
    s_nop 0
    buffer_load_dwordx4 v32, s[52:55], s15 offen offset:256 lds
    ds_read_b64_tr_b16 v[172:173], v37 offset:38912
    ds_read_b64_tr_b16 v[174:175], v37 offset:39424
    s_waitcnt lgkmcnt(6)
    s_add_u32 m0, s68, 56960
    s_nop 0
    buffer_load_dwordx4 v32, s[52:55], s15 offen offset:384 lds
    ds_read_b64_tr_b16 v[176:177], v38 offset:0
    ds_read_b64_tr_b16 v[178:179], v38 offset:512
    ds_read_b64_tr_b16 v[180:181], v38 offset:2048
    s_add_u32 m0, s68, 36864
    s_add_u32 s15, s71, 16384
    buffer_load_dwordx4 v32, s[52:55], s15 offen lds
    ds_read_b64_tr_b16 v[182:183], v38 offset:2560
    ds_read_b64_tr_b16 v[184:185], v38 offset:4096
    ds_read_b64_tr_b16 v[186:187], v38 offset:4608
    s_add_u32 m0, s68, 44928
    s_nop 0
    buffer_load_dwordx4 v32, s[52:55], s15 offen offset:128 lds
    ds_read_b64_tr_b16 v[188:189], v38 offset:6144
    ds_read_b64_tr_b16 v[190:191], v38 offset:6656
    s_waitcnt lgkmcnt(0)
    s_add_u32 m0, s68, 52992
    s_nop 0
    buffer_load_dwordx4 v32, s[52:55], s15 offen offset:256 lds
    v_mov_b32 v248, 0x3f803f80
    v_mov_b32 v249, 0x3f803f80
    v_mov_b32 v250, 0x3f803f80
    s_add_u32 m0, s68, 61056
    s_nop 0
    buffer_load_dwordx4 v32, s[52:55], s15 offen offset:384 lds
    v_mov_b32 v251, 0x3f803f80
    s_nop 1
    v_mfma_f32_32x32x16_bf16 v[224:239], v[128:131], v[248:251], 0
    v_mfma_f32_32x32x16_bf16 v[224:239], v[132:135], v[248:251], v[224:239]
    s_add_u32 m0, s68, 131072
    s_add_u32 s15, s71, 32768
    buffer_load_dwordx4 v32, s[52:55], s15 offen lds
    v_mfma_f32_32x32x16_bf16 v[224:239], v[136:139], v[248:251], v[224:239]
    v_mfma_f32_32x32x16_bf16 v[224:239], v[140:143], v[248:251], v[224:239]
    v_mfma_f32_32x32x16_bf16 v[224:239], v[144:147], v[248:251], v[224:239]
    s_add_u32 m0, s68, 139136
    s_nop 0
    buffer_load_dwordx4 v32, s[52:55], s15 offen offset:128 lds
    v_mfma_f32_32x32x16_bf16 v[224:239], v[148:151], v[248:251], v[224:239]
    v_mfma_f32_32x32x16_bf16 v[224:239], v[152:155], v[248:251], v[224:239]
    v_mfma_f32_32x32x16_bf16 v[224:239], v[156:159], v[248:251], v[224:239]
    s_add_u32 m0, s68, 147200
    s_nop 0
    buffer_load_dwordx4 v32, s[52:55], s15 offen offset:256 lds
    v_mfma_f32_32x32x16_bf16 v[224:239], v[160:163], v[248:251], v[224:239]
    v_mfma_f32_32x32x16_bf16 v[224:239], v[164:167], v[248:251], v[224:239]
    v_mfma_f32_32x32x16_bf16 v[224:239], v[168:171], v[248:251], v[224:239]
    s_add_u32 m0, s68, 155264
    s_nop 0
    buffer_load_dwordx4 v32, s[52:55], s15 offen offset:384 lds
    v_mfma_f32_32x32x16_bf16 v[224:239], v[172:175], v[248:251], v[224:239]
    v_mfma_f32_32x32x16_bf16 v[224:239], v[176:179], v[248:251], v[224:239]
    v_mfma_f32_32x32x16_bf16 v[224:239], v[180:183], v[248:251], v[224:239]
    s_add_u32 m0, s68, 135168
    s_add_u32 s15, s71, 49152
    buffer_load_dwordx4 v32, s[52:55], s15 offen lds
    v_mfma_f32_32x32x16_bf16 v[224:239], v[184:187], v[248:251], v[224:239]
    v_mfma_f32_32x32x16_bf16 v[224:239], v[188:191], v[248:251], v[224:239]
    s_add_u32 m0, s68, 143232
    s_nop 0
    buffer_load_dwordx4 v32, s[52:55], s15 offen offset:128 lds
    s_add_u32 m0, s68, 151296
    s_nop 0
    buffer_load_dwordx4 v32, s[52:55], s15 offen offset:256 lds
    s_add_u32 m0, s68, 159360
    s_nop 0
    buffer_load_dwordx4 v32, s[52:55], s15 offen offset:384 lds
    s_nop 2
    s_branch L_42
L_39:
    s_cmp_eq_u32 s3, 0
    s_cbranch_scc1 L_43
    ds_read_b64_tr_b16 v[160:161], v37 offset:32768
    ds_read_b64_tr_b16 v[162:163], v37 offset:33280
    ds_read_b64_tr_b16 v[164:165], v37 offset:34816
    ds_read_b64_tr_b16 v[166:167], v37 offset:35328
    ds_read_b64_tr_b16 v[168:169], v37 offset:36864
    ds_read_b64_tr_b16 v[170:171], v37 offset:37376
    ds_read_b64_tr_b16 v[172:173], v37 offset:38912
    ds_read_b64_tr_b16 v[174:175], v37 offset:39424
    s_waitcnt lgkmcnt(6)
    ds_read_b64_tr_b16 v[176:177], v38 offset:0
    ds_read_b64_tr_b16 v[178:179], v38 offset:512
    ds_read_b64_tr_b16 v[180:181], v38 offset:2048
    ds_read_b64_tr_b16 v[182:183], v38 offset:2560
    ds_read_b64_tr_b16 v[184:185], v38 offset:4096
    ds_read_b64_tr_b16 v[186:187], v38 offset:4608
    ds_read_b64_tr_b16 v[188:189], v38 offset:6144
    ds_read_b64_tr_b16 v[190:191], v38 offset:6656
    s_waitcnt lgkmcnt(0)
    v_mov_b32 v248, 0x3f803f80
    v_mov_b32 v249, 0x3f803f80
    v_mov_b32 v250, 0x3f803f80
    v_mov_b32 v251, 0x3f803f80
    s_nop 1
    v_mfma_f32_32x32x16_bf16 v[224:239], v[128:131], v[248:251], 0
    v_mfma_f32_32x32x16_bf16 v[224:239], v[132:135], v[248:251], v[224:239]
    v_mfma_f32_32x32x16_bf16 v[224:239], v[136:139], v[248:251], v[224:239]
    v_mfma_f32_32x32x16_bf16 v[224:239], v[140:143], v[248:251], v[224:239]
    v_mfma_f32_32x32x16_bf16 v[224:239], v[144:147], v[248:251], v[224:239]
    v_mfma_f32_32x32x16_bf16 v[224:239], v[148:151], v[248:251], v[224:239]
    v_mfma_f32_32x32x16_bf16 v[224:239], v[152:155], v[248:251], v[224:239]
    v_mfma_f32_32x32x16_bf16 v[224:239], v[156:159], v[248:251], v[224:239]
    v_mfma_f32_32x32x16_bf16 v[224:239], v[160:163], v[248:251], v[224:239]
    v_mfma_f32_32x32x16_bf16 v[224:239], v[164:167], v[248:251], v[224:239]
    v_mfma_f32_32x32x16_bf16 v[224:239], v[168:171], v[248:251], v[224:239]
    v_mfma_f32_32x32x16_bf16 v[224:239], v[172:175], v[248:251], v[224:239]
    v_mfma_f32_32x32x16_bf16 v[224:239], v[176:179], v[248:251], v[224:239]
    v_mfma_f32_32x32x16_bf16 v[224:239], v[180:183], v[248:251], v[224:239]
    v_mfma_f32_32x32x16_bf16 v[224:239], v[184:187], v[248:251], v[224:239]
    v_mfma_f32_32x32x16_bf16 v[224:239], v[188:191], v[248:251], v[224:239]
    s_nop 11
    s_branch L_42
L_43:
    s_mov_b32 s14, 0
    s_mov_b32 exec_lo, 0
    buffer_load_dwordx2 v[120:121], v39, s[64:67], s76 offen sc1
    buffer_load_dwordx2 v[122:123], v39, s[64:67], s76 offen sc1
    s_mov_b64 exec, 1
    buffer_store_dwordx2 v[34:35], v36, s[64:67], s75 offen sc1
    s_mov_b32 exec_lo, 0
    s_mov_b32 exec_hi, -1
    s_waitcnt vmcnt(1)
    v_cmp_ne_u64 vcc, s[12:13], v[122:123]
    s_nop 4
    s_cbranch_vccz L_42
L_44:
    buffer_load_dwordx2 v[120:121], v39, s[64:67], s76 offen sc1
    s_waitcnt vmcnt(0)
    v_cmp_ne_u64 vcc, s[12:13], v[120:121]
    s_nop 4
    s_cbranch_vccz L_42
    s_add_u32 s14, s14, 1
    s_cmp_lt_u32 s14, 8
    s_cbranch_scc1 L_44
    s_mov_b64 exec, -1
    buffer_load_dwordx2 v[120:121], v39, s[64:67], s76 offen sc1
    s_sleep 2
    buffer_load_dwordx2 v[122:123], v39, s[64:67], s76 offen sc1
    s_sleep 2
    buffer_load_dwordx2 v[124:125], v39, s[64:67], s76 offen sc1
    s_sleep 2
L_41:
    buffer_load_dwordx2 v[126:127], v39, s[64:67], s76 offen sc1
    s_waitcnt vmcnt(3)
    v_cmp_ne_u64 vcc, s[12:13], v[120:121]
    s_nop 1
    s_and_b32 s14, vcc_lo, vcc_hi
    s_nop 1
    s_cbranch_scc0 L_42
    buffer_load_dwordx2 v[120:121], v39, s[64:67], s76 offen sc1
    s_waitcnt vmcnt(3)
    v_cmp_ne_u64 vcc, s[12:13], v[122:123]
    s_nop 1
    s_and_b32 s14, vcc_lo, vcc_hi
    s_nop 1
    s_cbranch_scc0 L_42
    buffer_load_dwordx2 v[122:123], v39, s[64:67], s76 offen sc1
    s_waitcnt vmcnt(3)
    v_cmp_ne_u64 vcc, s[12:13], v[124:125]
    s_nop 1
    s_and_b32 s14, vcc_lo, vcc_hi
    s_nop 1
    s_cbranch_scc0 L_42
    buffer_load_dwordx2 v[124:125], v39, s[64:67], s76 offen sc1
    s_waitcnt vmcnt(3)
    v_cmp_ne_u64 vcc, s[12:13], v[126:127]
    s_nop 1
    s_and_b32 s14, vcc_lo, vcc_hi
    s_nop 1
    s_cbranch_scc0 L_42
    s_add_u32 s99, s99, 1
    s_cmp_lt_u32 s99, 0x10000
    s_cbranch_scc1 L_41
L_42:
    s_mov_b64 exec, -1
    s_barrier
    s_add_u32 s14, s5, 1
    s_and_b32 s14, s14, 3
    s_lshl_b32 s14, s14, 14
    s_add_u32 s14, s14, s72
    s_add_u32 s14, s14, 9437184
    buffer_load_dwordx4 v[64:67], v1, s[64:67], s14 offen sc1
    buffer_load_dwordx4 v[68:71], v1, s[64:67], s14 offen offset:1024 sc1
    s_add_u32 s14, s5, 2
    s_and_b32 s14, s14, 3
    s_lshl_b32 s14, s14, 14
    s_add_u32 s14, s14, s72
    s_add_u32 s14, s14, 9437184
    buffer_load_dwordx4 v[72:75], v1, s[64:67], s14 offen sc1
    buffer_load_dwordx4 v[76:79], v1, s[64:67], s14 offen offset:1024 sc1
    s_add_u32 s14, s5, 3
    s_and_b32 s14, s14, 3
    s_lshl_b32 s14, s14, 14
    s_add_u32 s14, s14, s72
    s_add_u32 s14, s14, 9437184
    buffer_load_dwordx4 v[80:83], v1, s[64:67], s14 offen sc1
    buffer_load_dwordx4 v[84:87], v1, s[64:67], s14 offen offset:1024 sc1
    s_cmp_lg_u32 s3, 0
    s_cbranch_scc1 L_45
    ds_read_b64_tr_b16 v[160:161], v37 offset:32768
    ds_read_b64_tr_b16 v[162:163], v37 offset:33280
    ds_read_b64_tr_b16 v[164:165], v37 offset:34816
    ds_read_b64_tr_b16 v[166:167], v37 offset:35328
    ds_read_b64_tr_b16 v[168:169], v37 offset:36864
    ds_read_b64_tr_b16 v[170:171], v37 offset:37376
    ds_read_b64_tr_b16 v[172:173], v37 offset:38912
    ds_read_b64_tr_b16 v[174:175], v37 offset:39424
    s_waitcnt lgkmcnt(6)
    ds_read_b64_tr_b16 v[176:177], v38 offset:0
    ds_read_b64_tr_b16 v[178:179], v38 offset:512
    ds_read_b64_tr_b16 v[180:181], v38 offset:2048
    ds_read_b64_tr_b16 v[182:183], v38 offset:2560
    ds_read_b64_tr_b16 v[184:185], v38 offset:4096
    ds_read_b64_tr_b16 v[186:187], v38 offset:4608
    ds_read_b64_tr_b16 v[188:189], v38 offset:6144
    ds_read_b64_tr_b16 v[190:191], v38 offset:6656
    s_waitcnt lgkmcnt(0)
    v_mov_b32 v248, 0x3f803f80
    v_mov_b32 v249, 0x3f803f80
    v_mov_b32 v250, 0x3f803f80
    v_mov_b32 v251, 0x3f803f80
    s_nop 1
    v_mfma_f32_32x32x16_bf16 v[224:239], v[128:131], v[248:251], 0
    v_mfma_f32_32x32x16_bf16 v[224:239], v[132:135], v[248:251], v[224:239]
    v_mfma_f32_32x32x16_bf16 v[224:239], v[136:139], v[248:251], v[224:239]
    v_mfma_f32_32x32x16_bf16 v[224:239], v[140:143], v[248:251], v[224:239]
    v_mfma_f32_32x32x16_bf16 v[224:239], v[144:147], v[248:251], v[224:239]
    v_mfma_f32_32x32x16_bf16 v[224:239], v[148:151], v[248:251], v[224:239]
    v_mfma_f32_32x32x16_bf16 v[224:239], v[152:155], v[248:251], v[224:239]
    v_mfma_f32_32x32x16_bf16 v[224:239], v[156:159], v[248:251], v[224:239]
    v_mfma_f32_32x32x16_bf16 v[224:239], v[160:163], v[248:251], v[224:239]
    v_mfma_f32_32x32x16_bf16 v[224:239], v[164:167], v[248:251], v[224:239]
    v_mfma_f32_32x32x16_bf16 v[224:239], v[168:171], v[248:251], v[224:239]
    v_mfma_f32_32x32x16_bf16 v[224:239], v[172:175], v[248:251], v[224:239]
    v_mfma_f32_32x32x16_bf16 v[224:239], v[176:179], v[248:251], v[224:239]
    v_mfma_f32_32x32x16_bf16 v[224:239], v[180:183], v[248:251], v[224:239]
    v_mfma_f32_32x32x16_bf16 v[224:239], v[184:187], v[248:251], v[224:239]
    v_mfma_f32_32x32x16_bf16 v[224:239], v[188:191], v[248:251], v[224:239]
    s_nop 11
L_45:
    v_mul_u32_u24 v32, 512, v3
    v_add_u32 v32, v32, v4
    s_lshl_b32 s71, s3, 12
    s_lshl_b32 s14, s5, 17
    s_add_u32 s71, s71, s14
    s_waitcnt vmcnt(4)
    v_mfma_f32_32x32x16_bf16 v[16:31], v[8:11], v[64:67], v[16:31]
    v_mfma_f32_32x32x16_bf16 v[16:31], v[12:15], v[68:71], v[16:31]
    s_waitcnt vmcnt(2)
    v_mfma_f32_32x32x16_bf16 v[16:31], v[8:11], v[72:75], v[16:31]
    v_mfma_f32_32x32x16_bf16 v[16:31], v[12:15], v[76:79], v[16:31]
    s_waitcnt vmcnt(0)
    v_mfma_f32_32x32x16_bf16 v[16:31], v[8:11], v[80:83], v[16:31]
    v_mfma_f32_32x32x16_bf16 v[16:31], v[12:15], v[84:87], v[16:31]
    v_add_u32 v120, s69, v1
    s_nop 10
    v_cvt_pk_bf16_f32 v192, v16, v17
    v_cvt_pk_bf16_f32 v193, v18, v19
    v_cvt_pk_bf16_f32 v194, v20, v21
    v_cvt_pk_bf16_f32 v195, v22, v23
    v_cvt_pk_bf16_f32 v196, v24, v25
    v_cvt_pk_bf16_f32 v197, v26, v27
    v_cvt_pk_bf16_f32 v198, v28, v29
    v_cvt_pk_bf16_f32 v199, v30, v31
    ds_write_b128 v120, v[192:195] offset:0
    ds_write_b128 v120, v[196:199] offset:1024
    v_pk_add_f32 v[112:113], v[16:17], v[18:19]
    v_pk_mul_f32 v[114:115], v[16:17], v[16:17]
    v_pk_fma_f32 v[114:115], v[18:19], v[18:19], v[114:115]
    v_pk_add_f32 v[112:113], v[112:113], v[20:21]
    v_pk_fma_f32 v[114:115], v[20:21], v[20:21], v[114:115]
    v_pk_add_f32 v[112:113], v[112:113], v[22:23]
    v_pk_fma_f32 v[114:115], v[22:23], v[22:23], v[114:115]
    v_pk_add_f32 v[112:113], v[112:113], v[24:25]
    v_pk_fma_f32 v[114:115], v[24:25], v[24:25], v[114:115]
    v_pk_add_f32 v[112:113], v[112:113], v[26:27]
    v_pk_fma_f32 v[114:115], v[26:27], v[26:27], v[114:115]
    v_pk_add_f32 v[112:113], v[112:113], v[28:29]
    v_pk_fma_f32 v[114:115], v[28:29], v[28:29], v[114:115]
    v_pk_add_f32 v[112:113], v[112:113], v[30:31]
    v_pk_fma_f32 v[114:115], v[30:31], v[30:31], v[114:115]
    v_add_f32 v112, v112, v113
    v_add_f32 v114, v114, v115
    s_nop 1
    v_permlane32_swap_b32 v112, v114
    v_add_f32 v112, v112, v114
    s_lshl_b32 s14, s3, 2
    v_lshlrev_b32 v7, 1, v1
    v_add_u32 v113, s14, v7
    ds_write_b32 v113, v112 offset:16384
    s_waitcnt lgkmcnt(0)
    s_barrier
    ds_read_b128 v[240:243], v7 offset:16384
    ds_read_b128 v[244:247], v7 offset:16400
    s_add_u32 m0, s11, 65536
    s_add_u32 s15, s71, 65536
    buffer_load_dwordx4 v32, s[52:55], s15 offen lds
    s_add_u32 m0, s11, 73600
    s_nop 0
    buffer_load_dwordx4 v32, s[52:55], s15 offen offset:128 lds
    s_add_u32 m0, s11, 81664
    s_nop 0
    buffer_load_dwordx4 v32, s[52:55], s15 offen offset:256 lds
    s_add_u32 m0, s11, 89728
    s_nop 0
    buffer_load_dwordx4 v32, s[52:55], s15 offen offset:384 lds
    ds_read_b128 v[64:67], v1 offset:0
    ds_read_b128 v[68:71], v1 offset:1024
    ds_read_b128 v[72:75], v1 offset:2048
    ds_read_b128 v[76:79], v1 offset:3072
    ds_read_b128 v[80:83], v1 offset:4096
    ds_read_b128 v[84:87], v1 offset:5120
    ds_read_b128 v[88:91], v1 offset:6144
    ds_read_b128 v[92:95], v1 offset:7168
    ds_read_b128 v[96:99], v1 offset:8192
    ds_read_b128 v[100:103], v1 offset:9216
    ds_read_b128 v[104:107], v1 offset:10240
    ds_read_b128 v[108:111], v1 offset:11264
    s_waitcnt lgkmcnt(10)
    v_mfma_f32_32x32x16_bf16 v[48:63], v[128:131], v[64:67], 0
    v_mfma_f32_32x32x16_bf16 v[48:63], v[132:135], v[68:71], v[48:63]
    ds_read_b128 v[64:67], v1 offset:12288
    s_waitcnt lgkmcnt(9)
    v_mfma_f32_32x32x16_bf16 v[48:63], v[136:139], v[72:75], v[48:63]
    ds_read_b128 v[68:71], v1 offset:13312
    v_mfma_f32_32x32x16_bf16 v[48:63], v[140:143], v[76:79], v[48:63]
    ds_read_b128 v[72:75], v1 offset:14336
    s_waitcnt lgkmcnt(9)
    v_mfma_f32_32x32x16_bf16 v[48:63], v[144:147], v[80:83], v[48:63]
    ds_read_b128 v[76:79], v1 offset:15360
    v_mfma_f32_32x32x16_bf16 v[48:63], v[148:151], v[84:87], v[48:63]
    v_pk_add_f32 v[240:241], v[240:241], v[242:243]
    v_pk_add_f32 v[244:245], v[244:245], v[246:247]
    v_pk_add_f32 v[240:241], v[240:241], v[244:245]
    v_add_f32 v240, v240, v241
    v_mul_f32 v240, 0x3b800000, v240
    v_mov_b32 v241, v240
    s_nop 1
    v_permlane32_swap_b32 v240, v241
    v_fma_f32 v241, -v240, v240, v241
    v_max_f32 v241, 0, v241
    v_add_f32 v241, 0x3727c5ac, v241
    v_rsq_f32 v242, v241
    s_nop 0
    v_mul_f32 v244, -v240, v242
    v_pk_mul_f32 v[224:225], v[224:225], v[244:245] op_sel_hi:[1,0]
    v_pk_mul_f32 v[226:227], v[226:227], v[244:245] op_sel_hi:[1,0]
    v_pk_mul_f32 v[228:229], v[228:229], v[244:245] op_sel_hi:[1,0]
    v_pk_mul_f32 v[230:231], v[230:231], v[244:245] op_sel_hi:[1,0]
    v_pk_mul_f32 v[232:233], v[232:233], v[244:245] op_sel_hi:[1,0]
    v_pk_mul_f32 v[234:235], v[234:235], v[244:245] op_sel_hi:[1,0]
    v_pk_mul_f32 v[236:237], v[236:237], v[244:245] op_sel_hi:[1,0]
    v_pk_mul_f32 v[238:239], v[238:239], v[244:245] op_sel_hi:[1,0]
    s_waitcnt lgkmcnt(8)
    v_mfma_f32_32x32x16_bf16 v[48:63], v[152:155], v[88:91], v[48:63]
    v_mfma_f32_32x32x16_bf16 v[48:63], v[156:159], v[92:95], v[48:63]
    s_waitcnt lgkmcnt(6)
    v_mfma_f32_32x32x16_bf16 v[48:63], v[160:163], v[96:99], v[48:63]
    v_mfma_f32_32x32x16_bf16 v[48:63], v[164:167], v[100:103], v[48:63]
    s_waitcnt lgkmcnt(4)
    v_mfma_f32_32x32x16_bf16 v[48:63], v[168:171], v[104:107], v[48:63]
    v_mfma_f32_32x32x16_bf16 v[48:63], v[172:175], v[108:111], v[48:63]
    s_waitcnt lgkmcnt(2)
    v_mfma_f32_32x32x16_bf16 v[48:63], v[176:179], v[64:67], v[48:63]
    v_mfma_f32_32x32x16_bf16 v[48:63], v[180:183], v[68:71], v[48:63]
    s_waitcnt lgkmcnt(0)
    v_mfma_f32_32x32x16_bf16 v[48:63], v[184:187], v[72:75], v[48:63]
    v_mfma_f32_32x32x16_bf16 v[48:63], v[188:191], v[76:79], v[48:63]
    s_add_u32 m0, s11, 98304
    s_add_u32 s15, s71, 98304
    buffer_load_dwordx4 v32, s[52:55], s15 offen lds
    s_add_u32 m0, s11, 106368
    s_nop 0
    buffer_load_dwordx4 v32, s[52:55], s15 offen offset:128 lds
    s_add_u32 m0, s11, 114432
    s_nop 0
    buffer_load_dwordx4 v32, s[52:55], s15 offen offset:256 lds
    s_add_u32 m0, s11, 122496
    s_nop 0
    buffer_load_dwordx4 v32, s[52:55], s15 offen offset:384 lds
    ds_read_b64_tr_b16 v[128:129], v37 offset:0
    ds_read_b64_tr_b16 v[130:131], v37 offset:512
    ds_read_b64_tr_b16 v[132:133], v37 offset:2048
    ds_read_b64_tr_b16 v[134:135], v37 offset:2560
    ds_read_b64_tr_b16 v[136:137], v37 offset:4096
    ds_read_b64_tr_b16 v[138:139], v37 offset:4608
    ds_read_b64_tr_b16 v[140:141], v37 offset:6144
    ds_read_b64_tr_b16 v[142:143], v37 offset:6656
    s_waitcnt lgkmcnt(6)
    ds_read_b64_tr_b16 v[144:145], v38 offset:32768
    ds_read_b64_tr_b16 v[146:147], v38 offset:33280
    ds_read_b64_tr_b16 v[148:149], v38 offset:34816
    ds_read_b64_tr_b16 v[150:151], v38 offset:35328
    ds_read_b64_tr_b16 v[152:153], v38 offset:36864
    ds_read_b64_tr_b16 v[154:155], v38 offset:37376
    ds_read_b64_tr_b16 v[156:157], v38 offset:38912
    ds_read_b64_tr_b16 v[158:159], v38 offset:39424
    v_pk_fma_f32 v[48:49], v[48:49], v[242:243], v[224:225] op_sel_hi:[1,0,1]
    v_pk_fma_f32 v[50:51], v[50:51], v[242:243], v[226:227] op_sel_hi:[1,0,1]
    v_pk_fma_f32 v[52:53], v[52:53], v[242:243], v[228:229] op_sel_hi:[1,0,1]
    v_pk_fma_f32 v[54:55], v[54:55], v[242:243], v[230:231] op_sel_hi:[1,0,1]
    v_pk_fma_f32 v[56:57], v[56:57], v[242:243], v[232:233] op_sel_hi:[1,0,1]
    v_pk_fma_f32 v[58:59], v[58:59], v[242:243], v[234:235] op_sel_hi:[1,0,1]
    v_pk_fma_f32 v[60:61], v[60:61], v[242:243], v[236:237] op_sel_hi:[1,0,1]
    v_pk_fma_f32 v[62:63], v[62:63], v[242:243], v[238:239] op_sel_hi:[1,0,1]
    s_mov_b32 s14, 0xbfb8aa3b
    s_mov_b32 s15, 0xbfb8aa3b
    v_pk_mul_f32 v[112:113], v[48:49], s[14:15]
    v_pk_mul_f32 v[114:115], v[50:51], s[14:15]
    v_pk_mul_f32 v[116:117], v[52:53], s[14:15]
    v_pk_mul_f32 v[118:119], v[54:55], s[14:15]
    v_pk_mul_f32 v[120:121], v[56:57], s[14:15]
    v_pk_mul_f32 v[122:123], v[58:59], s[14:15]
    v_pk_mul_f32 v[124:125], v[60:61], s[14:15]
    v_pk_mul_f32 v[126:127], v[62:63], s[14:15]
    v_exp_f32 v112, v112
    v_exp_f32 v113, v113
    v_exp_f32 v114, v114
    v_exp_f32 v115, v115
    v_exp_f32 v116, v116
    v_exp_f32 v117, v117
    v_exp_f32 v118, v118
    v_exp_f32 v119, v119
    v_exp_f32 v120, v120
    v_exp_f32 v121, v121
    v_exp_f32 v122, v122
    v_exp_f32 v123, v123
    v_exp_f32 v124, v124
    v_exp_f32 v125, v125
    v_exp_f32 v126, v126
    v_exp_f32 v127, v127
    v_pk_fma_f32 v[112:113], v[112:113], 2.0, 2.0 op_sel_hi:[1,0,0]
    v_pk_fma_f32 v[114:115], v[114:115], 2.0, 2.0 op_sel_hi:[1,0,0]
    v_pk_fma_f32 v[116:117], v[116:117], 2.0, 2.0 op_sel_hi:[1,0,0]
    v_pk_fma_f32 v[118:119], v[118:119], 2.0, 2.0 op_sel_hi:[1,0,0]
    v_pk_fma_f32 v[120:121], v[120:121], 2.0, 2.0 op_sel_hi:[1,0,0]
    v_pk_fma_f32 v[122:123], v[122:123], 2.0, 2.0 op_sel_hi:[1,0,0]
    v_pk_fma_f32 v[124:125], v[124:125], 2.0, 2.0 op_sel_hi:[1,0,0]
    v_pk_fma_f32 v[126:127], v[126:127], 2.0, 2.0 op_sel_hi:[1,0,0]
    v_rcp_f32 v112, v112
    v_rcp_f32 v113, v113
    v_rcp_f32 v114, v114
    v_rcp_f32 v115, v115
    v_rcp_f32 v116, v116
    v_rcp_f32 v117, v117
    v_rcp_f32 v118, v118
    v_rcp_f32 v119, v119
    v_rcp_f32 v120, v120
    v_rcp_f32 v121, v121
    v_rcp_f32 v122, v122
    v_rcp_f32 v123, v123
    v_rcp_f32 v124, v124
    v_rcp_f32 v125, v125
    v_rcp_f32 v126, v126
    v_rcp_f32 v127, v127
    v_pk_mul_f32 v[112:113], v[112:113], v[48:49]
    v_pk_mul_f32 v[114:115], v[114:115], v[50:51]
    v_pk_mul_f32 v[116:117], v[116:117], v[52:53]
    v_pk_mul_f32 v[118:119], v[118:119], v[54:55]
    v_pk_mul_f32 v[120:121], v[120:121], v[56:57]
    v_pk_mul_f32 v[122:123], v[122:123], v[58:59]
    v_pk_mul_f32 v[124:125], v[124:125], v[60:61]
    v_pk_mul_f32 v[126:127], v[126:127], v[62:63]
    v_cvt_pk_bf16_f32 v192, v112, v113
    v_cvt_pk_bf16_f32 v193, v114, v115
    v_cvt_pk_bf16_f32 v194, v116, v117
    v_cvt_pk_bf16_f32 v195, v118, v119
    v_cvt_pk_bf16_f32 v196, v120, v121
    v_cvt_pk_bf16_f32 v197, v122, v123
    v_cvt_pk_bf16_f32 v198, v124, v125
    v_cvt_pk_bf16_f32 v199, v126, v127
    v_add_u32 v7, s69, v1
    s_waitcnt vmcnt(0)
    s_barrier
    ds_write_b128 v7, v[192:195] offset:16384
    ds_write_b128 v7, v[196:199] offset:17408
    ds_read_b64_tr_b16 v[160:161], v37 offset:32768
    ds_read_b64_tr_b16 v[162:163], v37 offset:33280
    ds_read_b64_tr_b16 v[164:165], v37 offset:34816
    ds_read_b64_tr_b16 v[166:167], v37 offset:35328
    ds_read_b64_tr_b16 v[168:169], v37 offset:36864
    ds_read_b64_tr_b16 v[170:171], v37 offset:37376
    ds_read_b64_tr_b16 v[172:173], v37 offset:38912
    ds_read_b64_tr_b16 v[174:175], v37 offset:39424
    s_waitcnt lgkmcnt(8)
    s_barrier
    s_waitcnt lgkmcnt(2)
    ds_read_b128 v[64:67], v1 offset:16384
    ds_read_b128 v[68:71], v1 offset:17408
    ds_read_b128 v[72:75], v1 offset:18432
    ds_read_b128 v[76:79], v1 offset:19456
    ds_read_b128 v[80:83], v1 offset:20480
    ds_read_b128 v[84:87], v1 offset:21504
    ds_read_b128 v[88:91], v1 offset:22528
    ds_read_b128 v[92:95], v1 offset:23552
    ds_read_b128 v[96:99], v1 offset:24576
    ds_read_b128 v[100:103], v1 offset:25600
    ds_read_b128 v[104:107], v1 offset:26624
    ds_read_b128 v[108:111], v1 offset:27648
    s_waitcnt lgkmcnt(10)
    v_mfma_f32_32x32x16_bf16 v[48:63], v[128:131], v[64:67], 0
    v_mfma_f32_32x32x16_bf16 v[48:63], v[132:135], v[68:71], v[48:63]
    ds_read_b128 v[64:67], v1 offset:28672
    s_waitcnt lgkmcnt(9)
    v_mfma_f32_32x32x16_bf16 v[48:63], v[136:139], v[72:75], v[48:63]
    ds_read_b128 v[68:71], v1 offset:29696
    v_mfma_f32_32x32x16_bf16 v[48:63], v[140:143], v[76:79], v[48:63]
    ds_read_b128 v[72:75], v1 offset:30720
    s_waitcnt lgkmcnt(9)
    v_mfma_f32_32x32x16_bf16 v[48:63], v[144:147], v[80:83], v[48:63]
    ds_read_b128 v[76:79], v1 offset:31744
    v_mfma_f32_32x32x16_bf16 v[48:63], v[148:151], v[84:87], v[48:63]
    s_waitcnt lgkmcnt(6)
    ds_read_b64_tr_b16 v[176:177], v38 offset:0
    ds_read_b64_tr_b16 v[178:179], v38 offset:512
    ds_read_b64_tr_b16 v[180:181], v38 offset:2048
    ds_read_b64_tr_b16 v[182:183], v38 offset:2560
    ds_read_b64_tr_b16 v[184:185], v38 offset:4096
    ds_read_b64_tr_b16 v[186:187], v38 offset:4608
    ds_read_b64_tr_b16 v[188:189], v38 offset:6144
    ds_read_b64_tr_b16 v[190:191], v38 offset:6656
    s_waitcnt lgkmcnt(8)
    v_mfma_f32_32x32x16_bf16 v[48:63], v[152:155], v[88:91], v[48:63]
    v_mfma_f32_32x32x16_bf16 v[48:63], v[156:159], v[92:95], v[48:63]
    v_mfma_f32_32x32x16_bf16 v[48:63], v[160:163], v[96:99], v[48:63]
    v_mfma_f32_32x32x16_bf16 v[48:63], v[164:167], v[100:103], v[48:63]
    v_mfma_f32_32x32x16_bf16 v[48:63], v[168:171], v[104:107], v[48:63]
    v_mfma_f32_32x32x16_bf16 v[48:63], v[172:175], v[108:111], v[48:63]
    s_waitcnt lgkmcnt(0)
    v_mfma_f32_32x32x16_bf16 v[48:63], v[176:179], v[64:67], v[48:63]
    v_mfma_f32_32x32x16_bf16 v[48:63], v[180:183], v[68:71], v[48:63]
    v_mfma_f32_32x32x16_bf16 v[48:63], v[184:187], v[72:75], v[48:63]
    v_mfma_f32_32x32x16_bf16 v[48:63], v[188:191], v[76:79], v[48:63]
    s_nop 11
    v_cvt_pk_bf16_f32 v192, v48, v49
    v_cvt_pk_bf16_f32 v193, v50, v51
    v_cvt_pk_bf16_f32 v194, v52, v53
    v_cvt_pk_bf16_f32 v195, v54, v55
    v_cvt_pk_bf16_f32 v196, v56, v57
    v_cvt_pk_bf16_f32 v197, v58, v59
    v_cvt_pk_bf16_f32 v198, v60, v61
    v_cvt_pk_bf16_f32 v199, v62, v63
    s_add_u32 s14, s73, 13631488
    buffer_store_dwordx4 v[192:195], v1, s[64:67], s14 offen sc1
    buffer_store_dwordx4 v[196:199], v1, s[64:67], s14 offen offset:1024 sc1
    v_pk_add_f32 v[16:17], v[16:17], v[48:49]
    v_pk_add_f32 v[18:19], v[18:19], v[50:51]
    v_pk_add_f32 v[20:21], v[20:21], v[52:53]
    v_pk_add_f32 v[22:23], v[22:23], v[54:55]
    v_pk_add_f32 v[24:25], v[24:25], v[56:57]
    v_pk_add_f32 v[26:27], v[26:27], v[58:59]
    v_pk_add_f32 v[28:29], v[28:29], v[60:61]
    v_pk_add_f32 v[30:31], v[30:31], v[62:63]
    s_lshl_b32 s14, s5, 3
    s_add_u32 s75, s74, s14
    s_add_u32 s75, s75, 262144
    s_add_u32 s76, s74, 262144
    v_lshrrev_b32 v40, 3, v5
    v_cmp_eq_u32 s[78:79], s5, v40
    s_lshl_b32 s14, s7, 5
    v_add_u32 v40, s14, v5
    v_mov_b32 v41, 1000
    v_cmp_lt_u32 vcc, v40, v41
    s_nop 1
    s_and_b64 s[78:79], s[78:79], vcc
    v_lshlrev_b32 v33, 9, v5
    v_lshl_or_b32 v33, v6, 4, v33
    s_waitcnt vmcnt(0) lgkmcnt(0)
    s_barrier
    s_cmp_lg_u32 s3, 0
    s_cbranch_scc1 L_47
    v_mov_b32 v36, 0
    v_mov_b32 v34, s12
    v_mov_b32 v35, s13
    s_mov_b64 exec, 1
    s_lshl_b32 s14, s5, 7
    s_add_u32 s14, s14, s76
    buffer_store_dwordx2 v[34:35], v36, s[64:67], s14 offen offset:128
    s_mov_b64 exec, -1
L_47:
    s_cmp_eq_u32 s3, 0
    s_cbranch_scc1 L_50
    s_branch L_49
L_50:
    s_mov_b32 s14, 0
    s_mov_b32 exec_lo, 0
    buffer_load_dwordx2 v[120:121], v39, s[64:67], s76 offen sc1
    buffer_load_dwordx2 v[122:123], v39, s[64:67], s76 offen sc1
    s_mov_b64 exec, 1
    buffer_store_dwordx2 v[34:35], v36, s[64:67], s75 offen sc1
    s_mov_b32 exec_lo, 0
    s_mov_b32 exec_hi, -1
    s_waitcnt vmcnt(1)
    v_cmp_ne_u64 vcc, s[12:13], v[122:123]
    s_nop 4
    s_cbranch_vccz L_49
L_51:
    buffer_load_dwordx2 v[120:121], v39, s[64:67], s76 offen sc1
    s_waitcnt vmcnt(0)
    v_cmp_ne_u64 vcc, s[12:13], v[120:121]
    s_nop 4
    s_cbranch_vccz L_49
    s_add_u32 s14, s14, 1
    s_cmp_lt_u32 s14, 8
    s_cbranch_scc1 L_51
    s_mov_b64 exec, -1
    buffer_load_dwordx2 v[120:121], v39, s[64:67], s76 offen sc1
    s_sleep 2
    buffer_load_dwordx2 v[122:123], v39, s[64:67], s76 offen sc1
    s_sleep 2
    buffer_load_dwordx2 v[124:125], v39, s[64:67], s76 offen sc1
    s_sleep 2
L_48:
    buffer_load_dwordx2 v[126:127], v39, s[64:67], s76 offen sc1
    s_waitcnt vmcnt(3)
    v_cmp_ne_u64 vcc, s[12:13], v[120:121]
    s_nop 1
    s_and_b32 s14, vcc_lo, vcc_hi
    s_nop 1
    s_cbranch_scc0 L_49
    buffer_load_dwordx2 v[120:121], v39, s[64:67], s76 offen sc1
    s_waitcnt vmcnt(3)
    v_cmp_ne_u64 vcc, s[12:13], v[122:123]
    s_nop 1
    s_and_b32 s14, vcc_lo, vcc_hi
    s_nop 1
    s_cbranch_scc0 L_49
    buffer_load_dwordx2 v[122:123], v39, s[64:67], s76 offen sc1
    s_waitcnt vmcnt(3)
    v_cmp_ne_u64 vcc, s[12:13], v[124:125]
    s_nop 1
    s_and_b32 s14, vcc_lo, vcc_hi
    s_nop 1
    s_cbranch_scc0 L_49
    buffer_load_dwordx2 v[124:125], v39, s[64:67], s76 offen sc1
    s_waitcnt vmcnt(3)
    v_cmp_ne_u64 vcc, s[12:13], v[126:127]
    s_nop 1
    s_and_b32 s14, vcc_lo, vcc_hi
    s_nop 1
    s_cbranch_scc0 L_49
    s_add_u32 s99, s99, 1
    s_cmp_lt_u32 s99, 0x10000
    s_cbranch_scc1 L_48
L_49:
    s_mov_b64 exec, -1
    s_barrier
    s_cmp_eq_u64 s[78:79], 0
    s_cbranch_scc1 L_fin
    s_mov_b64 exec, s[78:79]
    s_add_u32 s14, s5, 1
    s_and_b32 s14, s14, 3
    s_lshl_b32 s14, s14, 14
    s_add_u32 s14, s14, s72
    s_add_u32 s14, s14, 13631488
    buffer_load_dwordx4 v[64:67], v1, s[64:67], s14 offen sc1
    buffer_load_dwordx4 v[68:71], v1, s[64:67], s14 offen offset:1024 sc1
    s_add_u32 s14, s5, 2
    s_and_b32 s14, s14, 3
    s_lshl_b32 s14, s14, 14
    s_add_u32 s14, s14, s72
    s_add_u32 s14, s14, 13631488
    buffer_load_dwordx4 v[72:75], v1, s[64:67], s14 offen sc1
    buffer_load_dwordx4 v[76:79], v1, s[64:67], s14 offen offset:1024 sc1
    s_add_u32 s14, s5, 3
    s_and_b32 s14, s14, 3
    s_lshl_b32 s14, s14, 14
    s_add_u32 s14, s14, s72
    s_add_u32 s14, s14, 13631488
    buffer_load_dwordx4 v[80:83], v1, s[64:67], s14 offen sc1
    buffer_load_dwordx4 v[84:87], v1, s[64:67], s14 offen offset:1024 sc1
    s_mov_b64 exec, -1
    s_waitcnt vmcnt(4)
    v_mfma_f32_32x32x16_bf16 v[16:31], v[8:11], v[64:67], v[16:31]
    v_mfma_f32_32x32x16_bf16 v[16:31], v[12:15], v[68:71], v[16:31]
    s_waitcnt vmcnt(2)
    v_mfma_f32_32x32x16_bf16 v[16:31], v[8:11], v[72:75], v[16:31]
    v_mfma_f32_32x32x16_bf16 v[16:31], v[12:15], v[76:79], v[16:31]
    s_waitcnt vmcnt(0)
    v_mfma_f32_32x32x16_bf16 v[16:31], v[8:11], v[80:83], v[16:31]
    v_mfma_f32_32x32x16_bf16 v[16:31], v[12:15], v[84:87], v[16:31]
    s_nop 11
    v_pk_add_f32 v[112:113], v[16:17], v[18:19]
    v_pk_mul_f32 v[114:115], v[16:17], v[16:17]
    v_pk_fma_f32 v[114:115], v[18:19], v[18:19], v[114:115]
    v_pk_add_f32 v[112:113], v[112:113], v[20:21]
    v_pk_fma_f32 v[114:115], v[20:21], v[20:21], v[114:115]
    v_pk_add_f32 v[112:113], v[112:113], v[22:23]
    v_pk_fma_f32 v[114:115], v[22:23], v[22:23], v[114:115]
    v_pk_add_f32 v[112:113], v[112:113], v[24:25]
    v_pk_fma_f32 v[114:115], v[24:25], v[24:25], v[114:115]
    v_pk_add_f32 v[112:113], v[112:113], v[26:27]
    v_pk_fma_f32 v[114:115], v[26:27], v[26:27], v[114:115]
    v_pk_add_f32 v[112:113], v[112:113], v[28:29]
    v_pk_fma_f32 v[114:115], v[28:29], v[28:29], v[114:115]
    v_pk_add_f32 v[112:113], v[112:113], v[30:31]
    v_pk_fma_f32 v[114:115], v[30:31], v[30:31], v[114:115]
    v_add_f32 v112, v112, v113
    v_add_f32 v114, v114, v115
    s_nop 1
    v_permlane32_swap_b32 v112, v114
    v_add_f32 v112, v112, v114
    s_lshl_b32 s14, s3, 2
    v_lshlrev_b32 v7, 1, v1
    v_add_u32 v113, s14, v7
    ds_write_b32 v113, v112 offset:16384
    s_waitcnt lgkmcnt(0)
    s_barrier
    ds_read_b128 v[112:115], v7 offset:16384
    ds_read_b128 v[116:119], v7 offset:16400
    v_add_u32 v7, s69, v1
    s_waitcnt lgkmcnt(0)
    v_pk_add_f32 v[112:113], v[112:113], v[114:115]
    v_pk_add_f32 v[116:117], v[116:117], v[118:119]
    v_pk_add_f32 v[112:113], v[112:113], v[116:117]
    v_add_f32 v112, v112, v113
    v_mul_f32 v112, 0x3b800000, v112
    v_mov_b32 v113, v112
    s_nop 1
    v_permlane32_swap_b32 v112, v113
    v_fma_f32 v113, -v112, v112, v113
    v_max_f32 v113, 0, v113
    v_add_f32 v113, 0x3727c5ac, v113
    v_rsq_f32 v114, v113
    s_nop 0
    v_mul_f32 v116, -v112, v114
    v_pk_fma_f32 v[118:119], v[16:17], v[114:115], v[116:117] op_sel_hi:[1,0,0]
    v_cvt_pk_bf16_f32 v192, v118, v119
    v_pk_fma_f32 v[112:113], v[18:19], v[114:115], v[116:117] op_sel_hi:[1,0,0]
    v_cvt_pk_bf16_f32 v193, v112, v113
    v_pk_fma_f32 v[118:119], v[20:21], v[114:115], v[116:117] op_sel_hi:[1,0,0]
    v_cvt_pk_bf16_f32 v194, v118, v119
    v_pk_fma_f32 v[112:113], v[22:23], v[114:115], v[116:117] op_sel_hi:[1,0,0]
    v_cvt_pk_bf16_f32 v195, v112, v113
    v_pk_fma_f32 v[118:119], v[24:25], v[114:115], v[116:117] op_sel_hi:[1,0,0]
    v_cvt_pk_bf16_f32 v196, v118, v119
    v_pk_fma_f32 v[112:113], v[26:27], v[114:115], v[116:117] op_sel_hi:[1,0,0]
    v_cvt_pk_bf16_f32 v197, v112, v113
    v_pk_fma_f32 v[118:119], v[28:29], v[114:115], v[116:117] op_sel_hi:[1,0,0]
    v_cvt_pk_bf16_f32 v198, v118, v119
    v_pk_fma_f32 v[112:113], v[30:31], v[114:115], v[116:117] op_sel_hi:[1,0,0]
    v_cvt_pk_bf16_f32 v199, v112, v113
    s_mov_b64 exec, s[78:79]
    buffer_store_dwordx4 v[192:195], v33, s[56:59], s70 offen
    buffer_store_dwordx4 v[196:199], v33, s[56:59], s70 offen offset:32
    s_mov_b64 exec, -1
    s_nop 0
L_fin:
L_end:
    s_endpgm
.section .rodata,"a"
.p2align 6
.amdhsa_kernel standalone__conformer_family_zipformer__speech_kernel
  .amdhsa_next_free_vgpr 256
  .amdhsa_next_free_sgpr 102
  .amdhsa_accum_offset 256
  .amdhsa_group_segment_fixed_size 0
  .amdhsa_kernarg_size 104
  .amdhsa_user_sgpr_count 2
  .amdhsa_user_sgpr_kernarg_segment_ptr 1
  .amdhsa_system_sgpr_workgroup_id_x 1
.end_amdhsa_kernel
```
